```python
import torch

def _softmax(x, axis=-1):
    return torch.softmax(x, dim=axis)
def _gelu(x):
    return torch.nn.functional.gelu(x, approximate="tanh")
def _silu(x):
    return torch.nn.functional.silu(x)
def _sigmoid(x):
    return torch.sigmoid(x)
def _layernorm(x, axis=-1, eps=1e-5):
    m = x.mean(dim=axis, keepdim=True)
    v = x.var(dim=axis, keepdim=True, unbiased=False)
    return (x - m) / torch.sqrt(v + eps)
def _scatter_add(tgt, idx, src, axis=0):
    return tgt.clone().index_add_(axis, idx, src)
def _segment_sum(src, seg, n):
    out = torch.zeros((n,) + src.shape[1:], dtype=src.dtype)
    return out.index_add_(0, seg, src)
def _pad(x, pw):
    flat = tuple(v for pair in reversed(pw) for v in pair)
    return torch.nn.functional.pad(x, flat)

kernel_name = 'interleave_layers__softmax_full_mha__dense_activation_silu__prompt'

def setup_inputs():

    _w = (lambda a: (lambda t: t.to(torch.bfloat16) if t.is_floating_point() else t)(torch.as_tensor(a)))
    def _A_setup():
        B, S, D = 1, 2048, 512
        return {
            "x": _w((lambda *s: torch.randn(*s, dtype=torch.bfloat16) * 0.05)(B, S, D)),
            "wqkv": _w((lambda *s: torch.randn(*s, dtype=torch.bfloat16) * 0.05)(D, 3 * D)),
            "wo": _w((lambda *s: torch.randn(*s, dtype=torch.bfloat16) * 0.05)(D, D)),
        }
    _A_in = _A_setup()

    def _B_setup():
        B, S, D, F = 1, 2048, 512, 1792
        return {
            "x": _w((lambda *s: torch.randn(*s, dtype=torch.bfloat16) * 0.05)(B, S, D)),
            "w1": _w((lambda *s: torch.randn(*s, dtype=torch.bfloat16) * 0.8)(D, F) * (D ** -0.5)),
            "w2": _w((lambda *s: torch.randn(*s, dtype=torch.bfloat16) * 0.2)(F, D) * (F ** -0.5)),
        }
    _B_in = _B_setup()

    return {
        "A_x": _A_in["x"],
        "A_wqkv": _A_in["wqkv"],
        "A_wo": _A_in["wo"],
        "B_x": _B_in["x"],
        "B_w1": _B_in["w1"],
        "B_w2": _B_in["w2"],
    }

def reference(A_x, A_wqkv, A_wo, B_x, B_w1, B_w2):
    def _A_ref(x, wqkv, wo):
        B, S, D = x.shape
        H = 32; Dh = D // H
        qkv = (lambda x, *d: x.permute(*d))((x @ wqkv).reshape(B, S, 3, H, Dh), 2, 0, 3, 1, 4)
        q, k, v = qkv[0], qkv[1], qkv[2]
        scale = Dh ** -0.5
        scores = torch.einsum("bhqd,bhkd->bhqk", q, k) * scale
        p = _softmax(scores, axis=-1)
        o = torch.einsum("bhqk,bhkd->bhqd", p, v)
        return (lambda x, *d: x.permute(*d))(o, 0, 2, 1, 3).reshape(B, S, D) @ wo

    def _B_ref(x, w1, w2):
        h = torch.einsum("bsd,df->bsf", x, w1)
        h = _silu(h)
        out = torch.einsum("bsf,fd->bsd", h, w2)
        return out

    x = A_x
    x = x + _A_ref(_layernorm(x, axis=-1), A_wqkv, A_wo)
    x = x + _B_ref(_layernorm(x, axis=-1), B_w1, B_w2)
    x = x + _A_ref(_layernorm(x, axis=-1), A_wqkv, A_wo)
    x = x + _B_ref(_layernorm(x, axis=-1), B_w1, B_w2)
    return x
```

```asm
; @launch kernel=prep_kernel grid=(240,1,1) block=(256,1,1) lds=1024
; @launch kernel=qkv_kernel grid=(256,1,1) block=(256,1,1) lds=98816
; @launch kernel=attn_kernel grid=(256,1,1) block=(512,1,1) lds=139264
; @launch kernel=outp_kernel grid=(256,1,1) block=(256,1,1) lds=49152
; @launch kernel=ffn1_kernel grid=(256,1,1) block=(256,1,1) lds=131072
; @launch kernel=ffn2_kernel grid=(256,1,1) block=(256,1,1) lds=49152
; @launch kernel=qkv_kernel grid=(256,1,1) block=(256,1,1) lds=98816
; @launch kernel=attn_kernel grid=(256,1,1) block=(512,1,1) lds=139264
; @launch kernel=outp_kernel grid=(256,1,1) block=(256,1,1) lds=49152
; @launch kernel=ffn1_kernel grid=(256,1,1) block=(256,1,1) lds=131072
; @launch kernel=ffn2_last_kernel grid=(256,1,1) block=(256,1,1) lds=49152
.amdgcn_target "amdgcn-amd-amdhsa--gfx950"
.text
.globl prep_kernel
.p2align 8
.type prep_kernel,@function
prep_kernel:
  s_cmp_ge_u32 s2, 240
  s_cbranch_scc1 prep_kernel_exit
  s_load_dwordx2 s[4:5], s[0:1], 64
  v_lshrrev_b32 v1, 6, v0
  v_and_b32 v0, 63, v0
  s_nop 0
  v_readfirstlane_b32 s3, v1
  v_and_b32 v2, 31, v0
  v_lshrrev_b32 v3, 5, v0
  v_lshlrev_b32 v4, 4, v0

  s_cmp_ge_u32 s2, 64
  s_cbranch_scc1 prep_kernel_wts
  s_load_dwordx2 s[6:7], s[0:1], 0
  s_waitcnt lgkmcnt(0)
  s_mov_b32 s8, s6
  s_mov_b32 s9, s7
  s_mov_b32 s10, 0x200000
  s_mov_b32 s11, 0x20000
  s_add_u32 s12, s4, 0x600000
  s_addc_u32 s13, s5, 0
  s_mov_b32 s14, 0x200000
  s_mov_b32 s15, 0x20000
  s_add_u32 s16, s4, 0x800000
  s_addc_u32 s17, s5, 0
  s_mov_b32 s18, 0x40000
  s_mov_b32 s19, 0x20000
  s_lshl_b32 s20, s2, 15
  s_lshl_b32 s21, s3, 8
  s_add_u32 s20, s20, s21
  v_lshlrev_b32 v5, 10, v2
  v_lshl_add_u32 v5, v3, 4, v5
  v_add_u32 v5, s20, v5

  buffer_load_dwordx4 v[16:19], v5, s[8:11], 0 offen offset:0
  buffer_load_dwordx4 v[20:23], v5, s[8:11], 0 offen offset:32
  buffer_load_dwordx4 v[24:27], v5, s[8:11], 0 offen offset:64
  buffer_load_dwordx4 v[28:31], v5, s[8:11], 0 offen offset:96
  buffer_load_dwordx4 v[32:35], v5, s[8:11], 0 offen offset:128
  buffer_load_dwordx4 v[36:39], v5, s[8:11], 0 offen offset:160
  buffer_load_dwordx4 v[40:43], v5, s[8:11], 0 offen offset:192
  buffer_load_dwordx4 v[44:47], v5, s[8:11], 0 offen offset:224
  s_lshl_b32 s20, s2, 15
  s_lshl_b32 s21, s3, 13
  s_add_u32 s20, s20, s21
  v_add_u32 v6, s20, v4
  s_lshl_b32 s20, s2, 12
  s_lshl_b32 s21, s3, 5
  s_add_u32 s20, s20, s21
  v_lshlrev_b32 v7, 7, v2
  v_add_u32 v7, s20, v7
  s_mov_b32 s22, 4096
  s_mov_b32 s23, 0x3f803f80

  s_waitcnt vmcnt(6)
  v_mov_b32 v8, 0
  v_mov_b32 v9, 0
  v_dot2_f32_bf16 v8, v16, s23, v8
  v_dot2_f32_bf16 v9, v16, v16, v9
  v_dot2_f32_bf16 v8, v17, s23, v8
  v_dot2_f32_bf16 v9, v17, v17, v9
  v_dot2_f32_bf16 v8, v18, s23, v8
  v_dot2_f32_bf16 v9, v18, v18, v9
  v_dot2_f32_bf16 v8, v19, s23, v8
  v_dot2_f32_bf16 v9, v19, v19, v9
  v_dot2_f32_bf16 v8, v20, s23, v8
  v_dot2_f32_bf16 v9, v20, v20, v9
  v_dot2_f32_bf16 v8, v21, s23, v8
  v_dot2_f32_bf16 v9, v21, v21, v9
  v_dot2_f32_bf16 v8, v22, s23, v8
  v_dot2_f32_bf16 v9, v22, v22, v9
  v_dot2_f32_bf16 v8, v23, s23, v8
  v_dot2_f32_bf16 v9, v23, v23, v9
  s_nop 3
  v_permlane32_swap_b32 v16, v18
  v_permlane32_swap_b32 v17, v19
  v_permlane32_swap_b32 v20, v22
  v_permlane32_swap_b32 v21, v23
  v_mov_b32 v10, v8
  v_mov_b32 v11, v9
  s_nop 1
  v_permlane32_swap_b32 v8, v10
  v_permlane32_swap_b32 v9, v11
  s_nop 1
  v_add_f32 v8, v8, v10
  v_add_f32 v9, v9, v11
  buffer_store_dwordx4 v[16:19], v6, s[12:15], 0 offen offset:0 sc1
  buffer_store_dwordx4 v[20:23], v6, s[12:15], 0 offen offset:1024 sc1
  buffer_store_dwordx2 v[8:9], v7, s[16:19], 0 offen offset:0
  s_nop 1
  s_waitcnt vmcnt(7)
  v_mov_b32 v8, 0
  v_mov_b32 v9, 0
  v_dot2_f32_bf16 v8, v24, s23, v8
  v_dot2_f32_bf16 v9, v24, v24, v9
  v_dot2_f32_bf16 v8, v25, s23, v8
  v_dot2_f32_bf16 v9, v25, v25, v9
  v_dot2_f32_bf16 v8, v26, s23, v8
  v_dot2_f32_bf16 v9, v26, v26, v9
  v_dot2_f32_bf16 v8, v27, s23, v8
  v_dot2_f32_bf16 v9, v27, v27, v9
  v_dot2_f32_bf16 v8, v28, s23, v8
  v_dot2_f32_bf16 v9, v28, v28, v9
  v_dot2_f32_bf16 v8, v29, s23, v8
  v_dot2_f32_bf16 v9, v29, v29, v9
  v_dot2_f32_bf16 v8, v30, s23, v8
  v_dot2_f32_bf16 v9, v30, v30, v9
  v_dot2_f32_bf16 v8, v31, s23, v8
  v_dot2_f32_bf16 v9, v31, v31, v9
  s_nop 3
  v_permlane32_swap_b32 v24, v26
  v_permlane32_swap_b32 v25, v27
  v_permlane32_swap_b32 v28, v30
  v_permlane32_swap_b32 v29, v31
  v_mov_b32 v10, v8
  v_mov_b32 v11, v9
  s_nop 1
  v_permlane32_swap_b32 v8, v10
  v_permlane32_swap_b32 v9, v11
  s_nop 1
  v_add_f32 v8, v8, v10
  v_add_f32 v9, v9, v11
  buffer_store_dwordx4 v[24:27], v6, s[12:15], 0 offen offset:2048 sc1
  buffer_store_dwordx4 v[28:31], v6, s[12:15], 0 offen offset:3072 sc1
  buffer_store_dwordx2 v[8:9], v7, s[16:19], 0 offen offset:8
  s_nop 1
  s_waitcnt vmcnt(8)
  v_mov_b32 v8, 0
  v_mov_b32 v9, 0
  v_dot2_f32_bf16 v8, v32, s23, v8
  v_dot2_f32_bf16 v9, v32, v32, v9
  v_dot2_f32_bf16 v8, v33, s23, v8
  v_dot2_f32_bf16 v9, v33, v33, v9
  v_dot2_f32_bf16 v8, v34, s23, v8
  v_dot2_f32_bf16 v9, v34, v34, v9
  v_dot2_f32_bf16 v8, v35, s23, v8
  v_dot2_f32_bf16 v9, v35, v35, v9
  v_dot2_f32_bf16 v8, v36, s23, v8
  v_dot2_f32_bf16 v9, v36, v36, v9
  v_dot2_f32_bf16 v8, v37, s23, v8
  v_dot2_f32_bf16 v9, v37, v37, v9
  v_dot2_f32_bf16 v8, v38, s23, v8
  v_dot2_f32_bf16 v9, v38, v38, v9
  v_dot2_f32_bf16 v8, v39, s23, v8
  v_dot2_f32_bf16 v9, v39, v39, v9
  s_nop 3
  v_permlane32_swap_b32 v32, v34
  v_permlane32_swap_b32 v33, v35
  v_permlane32_swap_b32 v36, v38
  v_permlane32_swap_b32 v37, v39
  v_mov_b32 v10, v8
  v_mov_b32 v11, v9
  s_nop 1
  v_permlane32_swap_b32 v8, v10
  v_permlane32_swap_b32 v9, v11
  s_nop 1
  v_add_f32 v8, v8, v10
  v_add_f32 v9, v9, v11
  buffer_store_dwordx4 v[32:35], v6, s[12:15], s22 offen offset:0 sc1
  buffer_store_dwordx4 v[36:39], v6, s[12:15], s22 offen offset:1024 sc1
  buffer_store_dwordx2 v[8:9], v7, s[16:19], 0 offen offset:16
  s_nop 1
  s_waitcnt vmcnt(9)
  v_mov_b32 v8, 0
  v_mov_b32 v9, 0
  v_dot2_f32_bf16 v8, v40, s23, v8
  v_dot2_f32_bf16 v9, v40, v40, v9
  v_dot2_f32_bf16 v8, v41, s23, v8
  v_dot2_f32_bf16 v9, v41, v41, v9
  v_dot2_f32_bf16 v8, v42, s23, v8
  v_dot2_f32_bf16 v9, v42, v42, v9
  v_dot2_f32_bf16 v8, v43, s23, v8
  v_dot2_f32_bf16 v9, v43, v43, v9
  v_dot2_f32_bf16 v8, v44, s23, v8
  v_dot2_f32_bf16 v9, v44, v44, v9
  v_dot2_f32_bf16 v8, v45, s23, v8
  v_dot2_f32_bf16 v9, v45, v45, v9
  v_dot2_f32_bf16 v8, v46, s23, v8
  v_dot2_f32_bf16 v9, v46, v46, v9
  v_dot2_f32_bf16 v8, v47, s23, v8
  v_dot2_f32_bf16 v9, v47, v47, v9
  s_nop 3
  v_permlane32_swap_b32 v40, v42
  v_permlane32_swap_b32 v41, v43
  v_permlane32_swap_b32 v44, v46
  v_permlane32_swap_b32 v45, v47
  v_mov_b32 v10, v8
  v_mov_b32 v11, v9
  s_nop 1
  v_permlane32_swap_b32 v8, v10
  v_permlane32_swap_b32 v9, v11
  s_nop 1
  v_add_f32 v8, v8, v10
  v_add_f32 v9, v9, v11
  buffer_store_dwordx4 v[40:43], v6, s[12:15], s22 offen offset:2048 sc1
  buffer_store_dwordx4 v[44:47], v6, s[12:15], s22 offen offset:3072 sc1
  buffer_store_dwordx2 v[8:9], v7, s[16:19], 0 offen offset:24
  s_nop 1
  s_branch prep_kernel_end
prep_kernel_wts:
  s_lshl_b32 s30, s3, 2
  s_mov_b32 s29, 32768
  s_cmp_ge_u32 s2, 112
  s_cbranch_scc1 prep_kernel_notq
  s_load_dwordx2 s[6:7], s[0:1], 8
  s_sub_u32 s26, s2, 64
  s_mov_b32 s25, 3072
  s_mov_b32 s27, 0
  s_mov_b32 s28, 1572864
  s_mov_b32 s32, 1572864
  s_mov_b32 s37, 48
  s_branch prep_kernel_pair

prep_kernel_notq:
  s_cmp_ge_u32 s2, 168
  s_cbranch_scc1 prep_kernel_not1
  s_load_dwordx2 s[6:7], s[0:1], 32
  s_sub_u32 s26, s2, 112
  s_mov_b32 s25, 3584
  s_mov_b32 s27, 1638400
  s_mov_b32 s28, 3473408
  s_mov_b32 s32, 1835008
  s_mov_b32 s37, 56
  s_branch prep_kernel_pair

prep_kernel_not1:
  s_mov_b32 s25, 1024
  s_mov_b32 s28, -1
  s_cmp_ge_u32 s2, 184
  s_cbranch_scc1 prep_kernel_noto
  s_load_dwordx2 s[6:7], s[0:1], 16
  s_sub_u32 s26, s2, 168
  s_mov_b32 s27, 3538944
  s_mov_b32 s32, 524288
  s_mov_b32 s37, 16
  s_branch prep_kernel_pair

prep_kernel_noto:
  s_load_dwordx2 s[6:7], s[0:1], 40
  s_sub_u32 s26, s2, 184
  s_lshl_b32 s26, s26, 2
  s_add_u32 s26, s26, s3
  s_lshr_b32 s30, s26, 4
  s_lshl_b32 s30, s30, 2
  s_and_b32 s26, s26, 15
  s_mov_b32 s27, 4063232
  s_mov_b32 s29, 114688
  s_mov_b32 s32, 1835008
  s_branch prep_kernel_go

prep_kernel_pair:
  s_or_b32 s33, s26, 15
  s_cmp_ge_u32 s33, s37
  s_cbranch_scc1 prep_kernel_go
  s_and_b32 s33, s26, 7
  s_lshl_b32 s33, s33, 1
  s_bfe_u32 s34, s26, 0x10003
  s_or_b32 s33, s33, s34
  s_and_b32 s26, s26, 0xfffffff0
  s_or_b32 s26, s26, s33

prep_kernel_go:
  v_mul_lo_u32 v5, v2, s25
  v_lshl_add_u32 v5, v3, 4, v5
  s_lshl_b32 s33, s26, 6
  s_lshl_b32 s34, s25, 5
  s_mul_i32 s35, s30, s34
  s_add_u32 s33, s33, s35
  v_add_u32 v5, s33, v5
  s_waitcnt lgkmcnt(0)
  s_mov_b32 s8, s6
  s_mov_b32 s9, s7
  s_mov_b32 s10, s32
  s_mov_b32 s11, 0x20000
  s_mov_b32 s36, 0

  buffer_load_dwordx4 v[64:67], v5, s[8:11], s36 offen
  buffer_load_dwordx4 v[68:71], v5, s[8:11], s36 offen offset:32
  s_add_u32 s36, s36, s34
  buffer_load_dwordx4 v[72:75], v5, s[8:11], s36 offen
  buffer_load_dwordx4 v[76:79], v5, s[8:11], s36 offen offset:32
  s_add_u32 s36, s36, s34
  buffer_load_dwordx4 v[80:83], v5, s[8:11], s36 offen
  buffer_load_dwordx4 v[84:87], v5, s[8:11], s36 offen offset:32
  s_add_u32 s36, s36, s34
  buffer_load_dwordx4 v[88:91], v5, s[8:11], s36 offen
  buffer_load_dwordx4 v[92:95], v5, s[8:11], s36 offen offset:32
  s_mov_b32 s12, s4
  s_mov_b32 s13, s5
  s_mov_b32 s14, 0x600000
  s_mov_b32 s15, 0x20000
  s_mul_i32 s33, s26, s29
  s_add_u32 s33, s33, s27
  s_lshl_b32 s35, s30, 11
  s_add_u32 s33, s33, s35
  v_add_u32 v6, s33, v4
  v_lshlrev_b32 v7, 3, v3
  v_sub_u32 v7, v2, v7

  v_mov_b32 v8, 0
  v_cmp_eq_u32 vcc, 0, v7
  s_nop 1
  v_mov_b32 v1, 0x3f80
  v_cndmask_b32 v8, v8, v1, vcc
  v_cmp_eq_u32 vcc, 1, v7
  s_nop 1
  v_mov_b32 v1, 0x3f800000
  v_cndmask_b32 v8, v8, v1, vcc
  v_mov_b32 v9, 0
  v_cmp_eq_u32 vcc, 2, v7
  s_nop 1
  v_mov_b32 v1, 0x3f80
  v_cndmask_b32 v9, v9, v1, vcc
  v_cmp_eq_u32 vcc, 3, v7
  s_nop 1
  v_mov_b32 v1, 0x3f800000
  v_cndmask_b32 v9, v9, v1, vcc
  v_mov_b32 v10, 0
  v_cmp_eq_u32 vcc, 4, v7
  s_nop 1
  v_mov_b32 v1, 0x3f80
  v_cndmask_b32 v10, v10, v1, vcc
  v_cmp_eq_u32 vcc, 5, v7
  s_nop 1
  v_mov_b32 v1, 0x3f800000
  v_cndmask_b32 v10, v10, v1, vcc
  v_mov_b32 v11, 0
  v_cmp_eq_u32 vcc, 6, v7
  s_nop 1
  v_mov_b32 v1, 0x3f80
  v_cndmask_b32 v11, v11, v1, vcc
  v_cmp_eq_u32 vcc, 7, v7
  s_nop 1
  v_mov_b32 v1, 0x3f800000
  v_cndmask_b32 v11, v11, v1, vcc
  v_mov_b32 v12, 0
  v_cmp_eq_u32 vcc, 16, v7
  s_nop 1
  v_mov_b32 v1, 0x3f80
  v_cndmask_b32 v12, v12, v1, vcc
  v_cmp_eq_u32 vcc, 17, v7
  s_nop 1
  v_mov_b32 v1, 0x3f800000
  v_cndmask_b32 v12, v12, v1, vcc
  v_mov_b32 v13, 0
  v_cmp_eq_u32 vcc, 18, v7
  s_nop 1
  v_mov_b32 v1, 0x3f80
  v_cndmask_b32 v13, v13, v1, vcc
  v_cmp_eq_u32 vcc, 19, v7
  s_nop 1
  v_mov_b32 v1, 0x3f800000
  v_cndmask_b32 v13, v13, v1, vcc
  v_mov_b32 v14, 0
  v_cmp_eq_u32 vcc, 20, v7
  s_nop 1
  v_mov_b32 v1, 0x3f80
  v_cndmask_b32 v14, v14, v1, vcc
  v_cmp_eq_u32 vcc, 21, v7
  s_nop 1
  v_mov_b32 v1, 0x3f800000
  v_cndmask_b32 v14, v14, v1, vcc
  v_mov_b32 v15, 0
  v_cmp_eq_u32 vcc, 22, v7
  s_nop 1
  v_mov_b32 v1, 0x3f80
  v_cndmask_b32 v15, v15, v1, vcc
  v_cmp_eq_u32 vcc, 23, v7
  s_nop 1
  v_mov_b32 v1, 0x3f800000
  v_cndmask_b32 v15, v15, v1, vcc
  v_mov_b32 v96, 0x3f803f80
  v_mov_b32 v97, 0x3f803f80
  v_mov_b32 v98, 0x3f803f80
  v_mov_b32 v99, 0x3f803f80
  v_mov_b32 v100, 0
  v_mov_b32 v101, 0
  v_mov_b32 v102, 0
  v_mov_b32 v103, 0
  v_mov_b32 v104, 0
  v_mov_b32 v105, 0
  v_mov_b32 v106, 0
  v_mov_b32 v107, 0
  v_mov_b32 v108, 0
  v_mov_b32 v109, 0
  v_mov_b32 v110, 0
  v_mov_b32 v111, 0
  v_mov_b32 v112, 0
  v_mov_b32 v113, 0
  v_mov_b32 v114, 0
  v_mov_b32 v115, 0
  s_mov_b32 s36, 0
  s_waitcnt vmcnt(6)
  v_mfma_f32_32x32x16_bf16 v[16:31], v[64:67], v[8:11], 0
  v_mfma_f32_32x32x16_bf16 v[16:31], v[68:71], v[12:15], v[16:31]
  s_nop 12
  v_cvt_pk_bf16_f32 v48, v16, v17
  v_cvt_pk_bf16_f32 v49, v18, v19
  v_cvt_pk_bf16_f32 v50, v20, v21
  v_cvt_pk_bf16_f32 v51, v22, v23
  v_cvt_pk_bf16_f32 v52, v24, v25
  v_cvt_pk_bf16_f32 v53, v26, v27
  v_cvt_pk_bf16_f32 v54, v28, v29
  v_cvt_pk_bf16_f32 v55, v30, v31
  s_nop 1
  buffer_store_dwordx4 v[48:51], v6, s[12:15], s36 offen sc1
  buffer_store_dwordx4 v[52:55], v6, s[12:15], s36 offen offset:1024 sc1
  v_mfma_f32_32x32x16_bf16 v[100:115], v[96:99], v[48:51], v[100:115]
  v_mfma_f32_32x32x16_bf16 v[100:115], v[96:99], v[52:55], v[100:115]
  s_add_u32 s36, s36, 2048
  s_waitcnt vmcnt(6)
  v_mfma_f32_32x32x16_bf16 v[32:47], v[72:75], v[8:11], 0
  v_mfma_f32_32x32x16_bf16 v[32:47], v[76:79], v[12:15], v[32:47]
  s_nop 12
  v_cvt_pk_bf16_f32 v56, v32, v33
  v_cvt_pk_bf16_f32 v57, v34, v35
  v_cvt_pk_bf16_f32 v58, v36, v37
  v_cvt_pk_bf16_f32 v59, v38, v39
  v_cvt_pk_bf16_f32 v60, v40, v41
  v_cvt_pk_bf16_f32 v61, v42, v43
  v_cvt_pk_bf16_f32 v62, v44, v45
  v_cvt_pk_bf16_f32 v63, v46, v47
  s_nop 1
  buffer_store_dwordx4 v[56:59], v6, s[12:15], s36 offen sc1
  buffer_store_dwordx4 v[60:63], v6, s[12:15], s36 offen offset:1024 sc1
  v_mfma_f32_32x32x16_bf16 v[100:115], v[96:99], v[56:59], v[100:115]
  v_mfma_f32_32x32x16_bf16 v[100:115], v[96:99], v[60:63], v[100:115]
  s_add_u32 s36, s36, 2048
  s_waitcnt vmcnt(6)
  v_mfma_f32_32x32x16_bf16 v[16:31], v[80:83], v[8:11], 0
  v_mfma_f32_32x32x16_bf16 v[16:31], v[84:87], v[12:15], v[16:31]
  s_nop 12
  v_cvt_pk_bf16_f32 v48, v16, v17
  v_cvt_pk_bf16_f32 v49, v18, v19
  v_cvt_pk_bf16_f32 v50, v20, v21
  v_cvt_pk_bf16_f32 v51, v22, v23
  v_cvt_pk_bf16_f32 v52, v24, v25
  v_cvt_pk_bf16_f32 v53, v26, v27
  v_cvt_pk_bf16_f32 v54, v28, v29
  v_cvt_pk_bf16_f32 v55, v30, v31
  s_nop 1
  buffer_store_dwordx4 v[48:51], v6, s[12:15], s36 offen sc1
  buffer_store_dwordx4 v[52:55], v6, s[12:15], s36 offen offset:1024 sc1
  v_mfma_f32_32x32x16_bf16 v[100:115], v[96:99], v[48:51], v[100:115]
  v_mfma_f32_32x32x16_bf16 v[100:115], v[96:99], v[52:55], v[100:115]
  s_add_u32 s36, s36, 2048
  s_waitcnt vmcnt(6)
  v_mfma_f32_32x32x16_bf16 v[32:47], v[88:91], v[8:11], 0
  v_mfma_f32_32x32x16_bf16 v[32:47], v[92:95], v[12:15], v[32:47]
  s_nop 12
  v_cvt_pk_bf16_f32 v56, v32, v33
  v_cvt_pk_bf16_f32 v57, v34, v35
  v_cvt_pk_bf16_f32 v58, v36, v37
  v_cvt_pk_bf16_f32 v59, v38, v39
  v_cvt_pk_bf16_f32 v60, v40, v41
  v_cvt_pk_bf16_f32 v61, v42, v43
  v_cvt_pk_bf16_f32 v62, v44, v45
  v_cvt_pk_bf16_f32 v63, v46, v47
  s_nop 1
  buffer_store_dwordx4 v[56:59], v6, s[12:15], s36 offen sc1
  buffer_store_dwordx4 v[60:63], v6, s[12:15], s36 offen offset:1024 sc1
  v_mfma_f32_32x32x16_bf16 v[100:115], v[96:99], v[56:59], v[100:115]
  v_mfma_f32_32x32x16_bf16 v[100:115], v[96:99], v[60:63], v[100:115]
  s_add_u32 s36, s36, 2048
  s_cmp_eq_u32 s28, -1
  s_cbranch_scc1 prep_kernel_end
  s_nop 12
  v_lshlrev_b32 v7, 2, v0
  s_lshl_b32 s33, s3, 8
  v_add_u32 v8, s33, v7
  ds_write_b32 v8, v100
  s_waitcnt lgkmcnt(0)
  s_barrier
  s_cmp_lg_u32 s3, 0
  s_cbranch_scc1 prep_kernel_end
  ds_read_b32 v9, v7
  ds_read_b32 v10, v7 offset:256
  ds_read_b32 v11, v7 offset:512
  ds_read_b32 v12, v7 offset:768
  s_waitcnt lgkmcnt(0)
  v_add_f32 v9, v9, v10
  v_add_f32 v11, v11, v12
  v_add_f32 v9, v9, v11
  v_sub_f32 v1, 0, v9
  v_cvt_pk_bf16_f32 v16, v1, v1
  v_lshlrev_b32 v17, 16, v16
  v_sub_f32 v17, v1, v17
  v_cvt_pk_bf16_f32 v16, v1, v17
  v_cmp_eq_u32 vcc, 0, v3
  s_nop 1
  v_cndmask_b32 v16, 0, v16, vcc
  v_mov_b32 v17, v16
  v_mov_b32 v18, 0
  v_mov_b32 v19, 0
  s_lshl_b32 s33, s26, 10
  s_add_u32 s33, s33, s28
  v_add_u32 v6, s33, v4
  buffer_store_dwordx4 v[16:19], v6, s[12:15], 0 offen sc1

prep_kernel_end:
prep_kernel_exit:
  s_endpgm
.text
.globl qkv_kernel
.p2align 8
.type qkv_kernel,@function
qkv_kernel:
  s_cmp_ge_u32 s2, 256
  s_cbranch_scc1 qkv_kernel_exit
  s_load_dwordx2 s[4:5], s[0:1], 64
  v_lshrrev_b32 v1, 6, v0
  v_and_b32 v0, 63, v0
  s_and_b32 s28, s2, 7
  v_readfirstlane_b32 s3, v1
  s_lshl_b32 s28, s28, 1
  s_bfe_u32 s29, s2, 0x10003
  s_add_u32 s28, s28, s29
  s_lshr_b32 s29, s2, 4
  s_lshl_b32 s28, s28, 2
  s_add_u32 s28, s28, s3
  v_and_b32 v2, 31, v0
  v_lshrrev_b32 v3, 5, v0
  v_lshlrev_b32 v4, 4, v0
  v_lshlrev_b32 v5, 7, v2
  v_lshl_add_u32 v5, v3, 6, v5
  s_lshl_b32 s30, s28, 12
  s_lshl_b32 s31, s28, 15
  s_waitcnt lgkmcnt(0)

  s_mov_b32 s16, s4
  s_mov_b32 s17, s5
  s_mov_b32 s18, 0x180000
  s_mov_b32 s19, 0x20000
  s_add_u32 s32, s29, 0
  s_add_u32 s33, s29, 16
  s_add_u32 s34, s29, 32
  s_lshl_b32 s37, s3, 11
  s_lshl_b32 s48, s32, 15
  s_add_u32 s48, s48, s37
  s_lshl_b32 s49, s33, 15
  s_add_u32 s49, s49, s37
  s_lshl_b32 s50, s34, 15
  s_add_u32 s50, s50, s37
  s_add_u32 m0, s37, 0
  s_add_u32 s36, s48, 0
  buffer_load_dwordx4 v4, s[16:19], s36 offen lds
  buffer_load_dwordx4 v4, s[16:19], s36 offen offset:1024 lds
  s_add_u32 m0, s37, 32768
  s_add_u32 s36, s49, 0
  buffer_load_dwordx4 v4, s[16:19], s36 offen lds
  buffer_load_dwordx4 v4, s[16:19], s36 offen offset:1024 lds
  s_add_u32 s8, s4, 0x600000
  s_addc_u32 s9, s5, 0
  s_mov_b32 s10, 0x200000
  s_mov_b32 s11, 0x20000
  buffer_load_dwordx4 a[0:3], v4, s[8:11], s31 offen offset:0
  buffer_load_dwordx4 a[4:7], v4, s[8:11], s31 offen offset:1024
  buffer_load_dwordx4 a[8:11], v4, s[8:11], s31 offen offset:2048
  buffer_load_dwordx4 a[12:15], v4, s[8:11], s31 offen offset:3072
  s_add_u32 s31, s31, 4096
  buffer_load_dwordx4 a[16:19], v4, s[8:11], s31 offen offset:0
  buffer_load_dwordx4 a[20:23], v4, s[8:11], s31 offen offset:1024
  buffer_load_dwordx4 a[24:27], v4, s[8:11], s31 offen offset:2048
  buffer_load_dwordx4 a[28:31], v4, s[8:11], s31 offen offset:3072
  s_add_u32 m0, s37, 8192
  s_add_u32 s36, s48, 8192
  buffer_load_dwordx4 v4, s[16:19], s36 offen lds
  buffer_load_dwordx4 v4, s[16:19], s36 offen offset:1024 lds
  s_add_u32 m0, s37, 40960
  s_add_u32 s36, s49, 8192
  buffer_load_dwordx4 v4, s[16:19], s36 offen lds
  buffer_load_dwordx4 v4, s[16:19], s36 offen offset:1024 lds
  s_add_u32 s31, s31, 4096
  buffer_load_dwordx4 a[32:35], v4, s[8:11], s31 offen offset:0
  buffer_load_dwordx4 a[36:39], v4, s[8:11], s31 offen offset:1024
  buffer_load_dwordx4 a[40:43], v4, s[8:11], s31 offen offset:2048
  buffer_load_dwordx4 a[44:47], v4, s[8:11], s31 offen offset:3072
  s_add_u32 s31, s31, 4096
  buffer_load_dwordx4 a[48:51], v4, s[8:11], s31 offen offset:0
  buffer_load_dwordx4 a[52:55], v4, s[8:11], s31 offen offset:1024
  buffer_load_dwordx4 a[56:59], v4, s[8:11], s31 offen offset:2048
  buffer_load_dwordx4 a[60:63], v4, s[8:11], s31 offen offset:3072
  s_add_u32 s12, s4, 0x800000
  s_addc_u32 s13, s5, 0
  s_mov_b32 s14, 0x40000
  s_mov_b32 s15, 0x20000
  s_add_u32 s20, s4, 0x180000
  s_addc_u32 s21, s5, 0
  s_mov_b32 s22, 0xc000
  s_mov_b32 s23, 0x20000
  s_add_u32 s24, s4, 0xa80000
  s_addc_u32 s25, s5, 0
  s_mov_b32 s26, 0x600000
  s_mov_b32 s27, 0x20000
  s_lshl_b32 s40, s29, 17
  s_lshl_b32 s41, s28, 10
  s_add_u32 s40, s40, s41
  s_add_u32 s41, s40, 0x10000
  s_add_u32 s42, s40, 0x200000
  s_add_u32 s43, s40, 0x210000
  s_add_u32 s44, s40, 0x400000
  v_lshrrev_b32 v6, 4, v2
  v_lshlrev_b32 v6, 16, v6
  v_lshl_add_u32 v6, v3, 8, v6
  v_and_b32 v7, 15, v2
  v_lshl_add_u32 v6, v7, 4, v6

  v_add_u32 v13, 0x10000, v4
  s_waitcnt vmcnt(20)
  s_barrier
  ds_read_b128 v[80:83], v4 offset:0
  ds_read_b128 v[84:87], v4 offset:32768
  ds_read_b128 v[88:91], v4 offset:1024
  ds_read_b128 v[92:95], v4 offset:33792
  ds_read_b128 v[96:99], v4 offset:2048
  ds_read_b128 v[100:103], v4 offset:34816
  ds_read_b128 v[104:107], v4 offset:3072
  ds_read_b128 v[108:111], v4 offset:35840
  s_waitcnt vmcnt(19)
  s_waitcnt lgkmcnt(4)
  v_mfma_f32_32x32x16_bf16 v[16:31], v[80:83], a[0:3], 0
  ds_read_b128 v[80:83], v4 offset:4096
  s_add_u32 m0, s37, 16384
  s_add_u32 s36, s48, 16384
  buffer_load_dwordx4 v4, s[16:19], s36 offen lds
  v_mfma_f32_32x32x16_bf16 v[32:47], v[84:87], a[0:3], 0
  ds_read_b128 v[84:87], v4 offset:36864
  buffer_load_dwordx4 v4, s[16:19], s36 offen offset:1024 lds
  s_waitcnt vmcnt(20)
  v_mfma_f32_32x32x16_bf16 v[16:31], v[88:91], a[4:7], v[16:31]
  ds_read_b128 v[88:91], v4 offset:5120
  s_add_u32 m0, s37, 49152
  s_add_u32 s36, s49, 16384
  buffer_load_dwordx4 v4, s[16:19], s36 offen lds
  v_mfma_f32_32x32x16_bf16 v[32:47], v[92:95], a[4:7], v[32:47]
  ds_read_b128 v[92:95], v4 offset:37888
  buffer_load_dwordx4 v4, s[16:19], s36 offen offset:1024 lds
  s_waitcnt vmcnt(21)
  s_waitcnt lgkmcnt(4)
  v_mfma_f32_32x32x16_bf16 v[16:31], v[96:99], a[8:11], v[16:31]
  ds_read_b128 v[96:99], v4 offset:6144
  s_add_u32 s31, s31, 4096
  buffer_load_dwordx4 a[64:67], v4, s[8:11], s31 offen offset:0
  v_mfma_f32_32x32x16_bf16 v[32:47], v[100:103], a[8:11], v[32:47]
  ds_read_b128 v[100:103], v4 offset:38912
  buffer_load_dwordx4 a[68:71], v4, s[8:11], s31 offen offset:1024
  s_waitcnt vmcnt(22)
  v_mfma_f32_32x32x16_bf16 v[16:31], v[104:107], a[12:15], v[16:31]
  ds_read_b128 v[104:107], v4 offset:7168
  buffer_load_dwordx4 a[72:75], v4, s[8:11], s31 offen offset:2048
  v_mfma_f32_32x32x16_bf16 v[32:47], v[108:111], a[12:15], v[32:47]
  ds_read_b128 v[108:111], v4 offset:39936
  buffer_load_dwordx4 a[76:79], v4, s[8:11], s31 offen offset:3072
  s_waitcnt vmcnt(23)
  s_waitcnt lgkmcnt(4)
  v_mfma_f32_32x32x16_bf16 v[16:31], v[80:83], a[16:19], v[16:31]
  s_waitcnt vmcnt(16)
  s_barrier
  ds_read_b128 v[80:83], v4 offset:8192
  s_add_u32 s31, s31, 4096
  buffer_load_dwordx4 a[80:83], v4, s[8:11], s31 offen offset:0
  v_mfma_f32_32x32x16_bf16 v[32:47], v[84:87], a[16:19], v[32:47]
  ds_read_b128 v[84:87], v4 offset:40960
  buffer_load_dwordx4 a[84:87], v4, s[8:11], s31 offen offset:1024
  v_mfma_f32_32x32x16_bf16 v[16:31], v[88:91], a[20:23], v[16:31]
  ds_read_b128 v[88:91], v4 offset:9216
  buffer_load_dwordx4 a[88:91], v4, s[8:11], s31 offen offset:2048
  v_mfma_f32_32x32x16_bf16 v[32:47], v[92:95], a[20:23], v[32:47]
  ds_read_b128 v[92:95], v4 offset:41984
  buffer_load_dwordx4 a[92:95], v4, s[8:11], s31 offen offset:3072
  s_waitcnt lgkmcnt(4)
  v_mfma_f32_32x32x16_bf16 v[16:31], v[96:99], a[24:27], v[16:31]
  ds_read_b128 v[96:99], v4 offset:10240
  buffer_load_dwordx4 v[128:131], v5, s[12:15], s30 offen offset:0
  v_mfma_f32_32x32x16_bf16 v[32:47], v[100:103], a[24:27], v[32:47]
  ds_read_b128 v[100:103], v4 offset:43008
  buffer_load_dwordx4 v[132:135], v5, s[12:15], s30 offen offset:16
  v_mfma_f32_32x32x16_bf16 v[16:31], v[104:107], a[28:31], v[16:31]
  ds_read_b128 v[104:107], v4 offset:11264
  buffer_load_dwordx4 v[136:139], v5, s[12:15], s30 offen offset:32
  v_mfma_f32_32x32x16_bf16 v[32:47], v[108:111], a[28:31], v[32:47]
  ds_read_b128 v[108:111], v4 offset:44032
  buffer_load_dwordx4 v[140:143], v5, s[12:15], s30 offen offset:48
  s_waitcnt vmcnt(23)
  s_waitcnt lgkmcnt(4)
  v_mfma_f32_32x32x16_bf16 v[16:31], v[80:83], a[32:35], v[16:31]
  ds_read_b128 v[80:83], v4 offset:12288
  s_add_u32 m0, s37, 24576
  s_add_u32 s36, s48, 24576
  buffer_load_dwordx4 v4, s[16:19], s36 offen lds
  v_mfma_f32_32x32x16_bf16 v[32:47], v[84:87], a[32:35], v[32:47]
  ds_read_b128 v[84:87], v4 offset:45056
  buffer_load_dwordx4 v4, s[16:19], s36 offen offset:1024 lds
  s_waitcnt vmcnt(24)
  v_mfma_f32_32x32x16_bf16 v[16:31], v[88:91], a[36:39], v[16:31]
  ds_read_b128 v[88:91], v4 offset:13312
  s_add_u32 m0, s37, 57344
  s_add_u32 s36, s49, 24576
  buffer_load_dwordx4 v4, s[16:19], s36 offen lds
  v_mfma_f32_32x32x16_bf16 v[32:47], v[92:95], a[36:39], v[32:47]
  ds_read_b128 v[92:95], v4 offset:46080
  buffer_load_dwordx4 v4, s[16:19], s36 offen offset:1024 lds
  s_waitcnt vmcnt(25)
  s_waitcnt lgkmcnt(4)
  v_mfma_f32_32x32x16_bf16 v[16:31], v[96:99], a[40:43], v[16:31]
  ds_read_b128 v[96:99], v4 offset:14336
  s_add_u32 s31, s31, 4096
  buffer_load_dwordx4 a[96:99], v4, s[8:11], s31 offen offset:0
  v_mfma_f32_32x32x16_bf16 v[32:47], v[100:103], a[40:43], v[32:47]
  ds_read_b128 v[100:103], v4 offset:47104
  buffer_load_dwordx4 a[100:103], v4, s[8:11], s31 offen offset:1024
  s_waitcnt vmcnt(26)
  v_mfma_f32_32x32x16_bf16 v[16:31], v[104:107], a[44:47], v[16:31]
  ds_read_b128 v[104:107], v4 offset:15360
  buffer_load_dwordx4 a[104:107], v4, s[8:11], s31 offen offset:2048
  v_mfma_f32_32x32x16_bf16 v[32:47], v[108:111], a[44:47], v[32:47]
  ds_read_b128 v[108:111], v4 offset:48128
  buffer_load_dwordx4 a[108:111], v4, s[8:11], s31 offen offset:3072
  s_waitcnt vmcnt(27)
  s_waitcnt lgkmcnt(4)
  v_mfma_f32_32x32x16_bf16 v[16:31], v[80:83], a[48:51], v[16:31]
  s_waitcnt vmcnt(20)
  s_barrier
  ds_read_b128 v[80:83], v4 offset:16384
  s_add_u32 s31, s31, 4096
  buffer_load_dwordx4 a[112:115], v4, s[8:11], s31 offen offset:0
  v_mfma_f32_32x32x16_bf16 v[32:47], v[84:87], a[48:51], v[32:47]
  ds_read_b128 v[84:87], v4 offset:49152
  buffer_load_dwordx4 a[116:119], v4, s[8:11], s31 offen offset:1024
  v_mfma_f32_32x32x16_bf16 v[16:31], v[88:91], a[52:55], v[16:31]
  ds_read_b128 v[88:91], v4 offset:17408
  buffer_load_dwordx4 a[120:123], v4, s[8:11], s31 offen offset:2048
  v_mfma_f32_32x32x16_bf16 v[32:47], v[92:95], a[52:55], v[32:47]
  ds_read_b128 v[92:95], v4 offset:50176
  buffer_load_dwordx4 a[124:127], v4, s[8:11], s31 offen offset:3072
  s_waitcnt lgkmcnt(4)
  v_mfma_f32_32x32x16_bf16 v[16:31], v[96:99], a[56:59], v[16:31]
  ds_read_b128 v[96:99], v4 offset:18432
  s_lshl_b32 s36, s32, 10
  buffer_load_dwordx4 v[112:115], v4, s[20:23], s36 offen
  v_mfma_f32_32x32x16_bf16 v[32:47], v[100:103], a[56:59], v[32:47]
  ds_read_b128 v[100:103], v4 offset:51200
  s_lshl_b32 s36, s33, 10
  buffer_load_dwordx4 v[116:119], v4, s[20:23], s36 offen
  v_mfma_f32_32x32x16_bf16 v[16:31], v[104:107], a[60:63], v[16:31]
  ds_read_b128 v[104:107], v4 offset:19456
  s_lshl_b32 s36, s34, 10
  buffer_load_dwordx4 v[120:123], v4, s[20:23], s36 offen
  v_mfma_f32_32x32x16_bf16 v[32:47], v[108:111], a[60:63], v[32:47]
  ds_read_b128 v[108:111], v4 offset:52224
  s_waitcnt vmcnt(26)
  s_waitcnt vmcnt(15)
  s_waitcnt lgkmcnt(4)
  v_mfma_f32_32x32x16_bf16 v[16:31], v[80:83], a[64:67], v[16:31]
  ds_read_b128 v[80:83], v4 offset:20480
  s_add_u32 m0, s37, 65536
  s_add_u32 s36, s50, 0
  buffer_load_dwordx4 v4, s[16:19], s36 offen lds
  v_add_f32 v8, v128, v130
  v_add_f32 v9, v129, v131
  v_add_f32 v8, v8, v132
  v_mfma_f32_32x32x16_bf16 v[32:47], v[84:87], a[64:67], v[32:47]
  ds_read_b128 v[84:87], v4 offset:53248
  buffer_load_dwordx4 v4, s[16:19], s36 offen offset:1024 lds
  v_add_f32 v9, v9, v133
  v_add_f32 v8, v8, v134
  v_add_f32 v9, v9, v135
  v_mfma_f32_32x32x16_bf16 v[16:31], v[88:91], a[68:71], v[16:31]
  ds_read_b128 v[88:91], v4 offset:21504
  s_add_u32 m0, s37, 73728
  s_add_u32 s36, s50, 8192
  buffer_load_dwordx4 v4, s[16:19], s36 offen lds
  v_add_f32 v8, v8, v136
  v_add_f32 v9, v9, v137
  v_add_f32 v8, v8, v138
  v_mfma_f32_32x32x16_bf16 v[32:47], v[92:95], a[68:71], v[32:47]
  ds_read_b128 v[92:95], v4 offset:54272
  buffer_load_dwordx4 v4, s[16:19], s36 offen offset:1024 lds
  v_add_f32 v9, v9, v139
  v_add_f32 v8, v8, v140
  v_add_f32 v9, v9, v141
  s_waitcnt lgkmcnt(4)
  v_mfma_f32_32x32x16_bf16 v[16:31], v[96:99], a[72:75], v[16:31]
  ds_read_b128 v[96:99], v4 offset:22528
  s_add_u32 m0, s37, 81920
  s_add_u32 s36, s50, 16384
  buffer_load_dwordx4 v4, s[16:19], s36 offen lds
  v_add_f32 v8, v8, v142
  v_add_f32 v9, v9, v143
  v_mov_b32 v10, v8
  v_mfma_f32_32x32x16_bf16 v[32:47], v[100:103], a[72:75], v[32:47]
  ds_read_b128 v[100:103], v4 offset:55296
  buffer_load_dwordx4 v4, s[16:19], s36 offen offset:1024 lds
  v_mov_b32 v11, v9
  s_nop 1
  v_permlane32_swap_b32 v8, v10
  v_mfma_f32_32x32x16_bf16 v[16:31], v[104:107], a[76:79], v[16:31]
  ds_read_b128 v[104:107], v4 offset:23552
  s_add_u32 m0, s37, 90112
  s_add_u32 s36, s50, 24576
  buffer_load_dwordx4 v4, s[16:19], s36 offen lds
  v_permlane32_swap_b32 v9, v11
  s_nop 1
  v_add_f32 v8, v8, v10
  v_mfma_f32_32x32x16_bf16 v[32:47], v[108:111], a[76:79], v[32:47]
  ds_read_b128 v[108:111], v4 offset:56320
  buffer_load_dwordx4 v4, s[16:19], s36 offen offset:1024 lds
  v_add_f32 v9, v9, v11
  v_mul_f32 v8, 0x3b000000, v8
  v_mul_f32 v9, 0x3b000000, v9
  s_waitcnt lgkmcnt(4)
  v_mfma_f32_32x32x16_bf16 v[16:31], v[80:83], a[80:83], v[16:31]
  s_waitcnt vmcnt(19)
  s_barrier
  ds_read_b128 v[80:83], v4 offset:24576
  v_fma_f32 v9, -v8, v8, v9
  v_max_f32 v9, 0, v9
  v_add_f32 v9, 0x3727c5ac, v9
  v_mfma_f32_32x32x16_bf16 v[32:47], v[84:87], a[80:83], v[32:47]
  ds_read_b128 v[84:87], v4 offset:57344
  v_rsq_f32 v9, v9
  v_cvt_pk_bf16_f32 v144, v8, v8
  v_and_b32 v10, 0xffff0000, v144
  v_mfma_f32_32x32x16_bf16 v[16:31], v[88:91], a[84:87], v[16:31]
  ds_read_b128 v[88:91], v4 offset:25600
  v_sub_f32 v10, v8, v10
  v_cvt_pk_bf16_f32 v145, v10, v10
  v_cmp_eq_u32 vcc, 0, v3
  v_mfma_f32_32x32x16_bf16 v[32:47], v[92:95], a[84:87], v[32:47]
  ds_read_b128 v[92:95], v4 offset:58368
  v_mov_b32 v146, 0
  v_mov_b32 v147, 0
  v_cndmask_b32 v144, 0, v144, vcc
  s_waitcnt lgkmcnt(4)
  v_mfma_f32_32x32x16_bf16 v[16:31], v[96:99], a[88:91], v[16:31]
  ds_read_b128 v[96:99], v4 offset:26624
  v_cndmask_b32 v145, 0, v145, vcc
  s_lshl_b32 s45, s3, 7
  s_add_u32 s45, s45, 98304
  v_mfma_f32_32x32x16_bf16 v[32:47], v[100:103], a[88:91], v[32:47]
  ds_read_b128 v[100:103], v4 offset:59392
  v_lshl_add_u32 v10, v2, 2, s45
  v_lshl_add_u32 v11, v3, 4, s45
  ds_write_b32 v10, v9
  v_mfma_f32_32x32x16_bf16 v[16:31], v[104:107], a[92:95], v[16:31]
  ds_read_b128 v[104:107], v4 offset:27648
  v_mul_f32 v12, 0x3eb8aa3b, v9
  s_waitcnt lgkmcnt(0)
  ds_read_b128 v[164:167], v11 offset:0
  v_mfma_f32_32x32x16_bf16 v[32:47], v[108:111], a[92:95], v[32:47]
  ds_read_b128 v[108:111], v4 offset:60416
  ds_read_b128 v[168:171], v11 offset:32
  ds_read_b128 v[172:175], v11 offset:64
  ds_read_b128 v[176:179], v11 offset:96
  s_waitcnt vmcnt(18)
  s_waitcnt lgkmcnt(4)
  v_mfma_f32_32x32x16_bf16 v[16:31], v[80:83], a[96:99], v[16:31]
  ds_read_b128 v[80:83], v4 offset:28672
  s_waitcnt lgkmcnt(0)
  v_mfma_f32_32x32x16_bf16 v[32:47], v[84:87], a[96:99], v[32:47]
  ds_read_b128 v[84:87], v4 offset:61440
  s_waitcnt vmcnt(17)
  v_mfma_f32_32x32x16_bf16 v[16:31], v[88:91], a[100:103], v[16:31]
  ds_read_b128 v[88:91], v4 offset:29696
  v_mfma_f32_32x32x16_bf16 v[32:47], v[92:95], a[100:103], v[32:47]
  ds_read_b128 v[92:95], v4 offset:62464
  s_waitcnt vmcnt(16)
  s_waitcnt lgkmcnt(4)
  v_mfma_f32_32x32x16_bf16 v[16:31], v[96:99], a[104:107], v[16:31]
  ds_read_b128 v[96:99], v4 offset:30720
  v_mfma_f32_32x32x16_bf16 v[32:47], v[100:103], a[104:107], v[32:47]
  ds_read_b128 v[100:103], v4 offset:63488
  s_waitcnt vmcnt(15)
  v_mfma_f32_32x32x16_bf16 v[16:31], v[104:107], a[108:111], v[16:31]
  ds_read_b128 v[104:107], v4 offset:31744
  v_mfma_f32_32x32x16_bf16 v[32:47], v[108:111], a[108:111], v[32:47]
  ds_read_b128 v[108:111], v4 offset:64512
  s_waitcnt vmcnt(14)
  s_waitcnt lgkmcnt(4)
  v_mfma_f32_32x32x16_bf16 v[16:31], v[80:83], a[112:115], v[16:31]
  s_waitcnt vmcnt(0)
  s_barrier
  ds_read_b128 v[80:83], v13 offset:0
  v_mfma_f32_32x32x16_bf16 v[32:47], v[84:87], a[112:115], v[32:47]
  ds_read_b128 v[84:87], v13 offset:1024
  v_mfma_f32_32x32x16_bf16 v[16:31], v[88:91], a[116:119], v[16:31]
  ds_read_b128 v[88:91], v13 offset:2048
  v_mfma_f32_32x32x16_bf16 v[32:47], v[92:95], a[116:119], v[32:47]
  ds_read_b128 v[92:95], v13 offset:3072
  s_waitcnt lgkmcnt(4)
  v_mfma_f32_32x32x16_bf16 v[16:31], v[96:99], a[120:123], v[16:31]
  ds_read_b128 v[96:99], v13 offset:4096
  v_mfma_f32_32x32x16_bf16 v[32:47], v[100:103], a[120:123], v[32:47]
  ds_read_b128 v[100:103], v13 offset:5120
  v_mfma_f32_32x32x16_bf16 v[16:31], v[104:107], a[124:127], v[16:31]
  ds_read_b128 v[104:107], v13 offset:6144
  v_mfma_f32_32x32x16_bf16 v[32:47], v[108:111], a[124:127], v[32:47]
  ds_read_b128 v[108:111], v13 offset:7168
  v_mfma_f32_32x32x16_bf16 v[16:31], v[112:115], v[144:147], v[16:31]
  v_mfma_f32_32x32x16_bf16 v[32:47], v[116:119], v[144:147], v[32:47]
  s_waitcnt lgkmcnt(4)
  v_mfma_f32_32x32x16_bf16 v[48:63], a[0:3], v[80:83], 0
  ds_read_b128 v[80:83], v13 offset:8192
  v_mfma_f32_32x32x16_bf16 v[48:63], a[4:7], v[84:87], v[48:63]
  ds_read_b128 v[84:87], v13 offset:9216
  v_mfma_f32_32x32x16_bf16 v[48:63], a[8:11], v[88:91], v[48:63]
  ds_read_b128 v[88:91], v13 offset:10240
  v_mfma_f32_32x32x16_bf16 v[48:63], a[12:15], v[92:95], v[48:63]
  ds_read_b128 v[92:95], v13 offset:11264
  s_waitcnt lgkmcnt(4)
  v_mfma_f32_32x32x16_bf16 v[48:63], a[16:19], v[96:99], v[48:63]
  ds_read_b128 v[96:99], v13 offset:12288
  v_mfma_f32_32x32x16_bf16 v[48:63], a[20:23], v[100:103], v[48:63]
  ds_read_b128 v[100:103], v13 offset:13312
  v_pk_mul_f32 v[16:17], v[12:13], v[16:17] op_sel_hi:[0,1]
  v_pk_mul_f32 v[18:19], v[12:13], v[18:19] op_sel_hi:[0,1]
  v_mfma_f32_32x32x16_bf16 v[48:63], a[24:27], v[104:107], v[48:63]
  ds_read_b128 v[104:107], v13 offset:14336
  v_pk_mul_f32 v[20:21], v[12:13], v[20:21] op_sel_hi:[0,1]
  v_pk_mul_f32 v[22:23], v[12:13], v[22:23] op_sel_hi:[0,1]
  v_mfma_f32_32x32x16_bf16 v[48:63], a[28:31], v[108:111], v[48:63]
  ds_read_b128 v[108:111], v13 offset:15360
  v_pk_mul_f32 v[24:25], v[12:13], v[24:25] op_sel_hi:[0,1]
  v_pk_mul_f32 v[26:27], v[12:13], v[26:27] op_sel_hi:[0,1]
  s_waitcnt lgkmcnt(4)
  v_mfma_f32_32x32x16_bf16 v[48:63], a[32:35], v[80:83], v[48:63]
  ds_read_b128 v[80:83], v13 offset:16384
  v_pk_mul_f32 v[28:29], v[12:13], v[28:29] op_sel_hi:[0,1]
  v_pk_mul_f32 v[30:31], v[12:13], v[30:31] op_sel_hi:[0,1]
  v_mfma_f32_32x32x16_bf16 v[48:63], a[36:39], v[84:87], v[48:63]
  ds_read_b128 v[84:87], v13 offset:17408
  v_cvt_pk_bf16_f32 v148, v16, v17
  v_cvt_pk_bf16_f32 v149, v18, v19
  v_mfma_f32_32x32x16_bf16 v[48:63], a[40:43], v[88:91], v[48:63]
  ds_read_b128 v[88:91], v13 offset:18432
  v_cvt_pk_bf16_f32 v150, v20, v21
  v_cvt_pk_bf16_f32 v151, v22, v23
  v_mfma_f32_32x32x16_bf16 v[48:63], a[44:47], v[92:95], v[48:63]
  ds_read_b128 v[92:95], v13 offset:19456
  v_cvt_pk_bf16_f32 v152, v24, v25
  v_cvt_pk_bf16_f32 v153, v26, v27
  s_waitcnt lgkmcnt(4)
  v_mfma_f32_32x32x16_bf16 v[48:63], a[48:51], v[96:99], v[48:63]
  ds_read_b128 v[96:99], v13 offset:20480
  v_cvt_pk_bf16_f32 v154, v28, v29
  v_cvt_pk_bf16_f32 v155, v30, v31
  v_mfma_f32_32x32x16_bf16 v[48:63], a[52:55], v[100:103], v[48:63]
  ds_read_b128 v[100:103], v13 offset:21504
  buffer_store_dwordx4 v[148:151], v4, s[24:27], s40 offen sc1
  buffer_store_dwordx4 v[152:155], v4, s[24:27], s41 offen sc1
  v_mfma_f32_32x32x16_bf16 v[48:63], a[56:59], v[104:107], v[48:63]
  ds_read_b128 v[104:107], v13 offset:22528
  v_pk_mul_f32 v[32:33], v[8:9], v[32:33] op_sel:[1,0] op_sel_hi:[1,1]
  v_pk_mul_f32 v[34:35], v[8:9], v[34:35] op_sel:[1,0] op_sel_hi:[1,1]
  v_mfma_f32_32x32x16_bf16 v[48:63], a[60:63], v[108:111], v[48:63]
  ds_read_b128 v[108:111], v13 offset:23552
  v_pk_mul_f32 v[36:37], v[8:9], v[36:37] op_sel:[1,0] op_sel_hi:[1,1]
  v_pk_mul_f32 v[38:39], v[8:9], v[38:39] op_sel:[1,0] op_sel_hi:[1,1]
  s_waitcnt lgkmcnt(4)
  v_mfma_f32_32x32x16_bf16 v[48:63], a[64:67], v[80:83], v[48:63]
  ds_read_b128 v[80:83], v13 offset:24576
  v_pk_mul_f32 v[40:41], v[8:9], v[40:41] op_sel:[1,0] op_sel_hi:[1,1]
  v_pk_mul_f32 v[42:43], v[8:9], v[42:43] op_sel:[1,0] op_sel_hi:[1,1]
  v_mfma_f32_32x32x16_bf16 v[48:63], a[68:71], v[84:87], v[48:63]
  ds_read_b128 v[84:87], v13 offset:25600
  v_pk_mul_f32 v[44:45], v[8:9], v[44:45] op_sel:[1,0] op_sel_hi:[1,1]
  v_pk_mul_f32 v[46:47], v[8:9], v[46:47] op_sel:[1,0] op_sel_hi:[1,1]
  v_mfma_f32_32x32x16_bf16 v[48:63], a[72:75], v[88:91], v[48:63]
  ds_read_b128 v[88:91], v13 offset:26624
  v_cvt_pk_bf16_f32 v148, v32, v33
  v_cvt_pk_bf16_f32 v149, v34, v35
  v_mfma_f32_32x32x16_bf16 v[48:63], a[76:79], v[92:95], v[48:63]
  ds_read_b128 v[92:95], v13 offset:27648
  v_cvt_pk_bf16_f32 v150, v36, v37
  v_cvt_pk_bf16_f32 v151, v38, v39
  s_waitcnt lgkmcnt(4)
  v_mfma_f32_32x32x16_bf16 v[48:63], a[80:83], v[96:99], v[48:63]
  ds_read_b128 v[96:99], v13 offset:28672
  v_cvt_pk_bf16_f32 v152, v40, v41
  v_cvt_pk_bf16_f32 v153, v42, v43
  v_mfma_f32_32x32x16_bf16 v[48:63], a[84:87], v[100:103], v[48:63]
  ds_read_b128 v[100:103], v13 offset:29696
  v_cvt_pk_bf16_f32 v154, v44, v45
  v_cvt_pk_bf16_f32 v155, v46, v47
  v_mfma_f32_32x32x16_bf16 v[48:63], a[88:91], v[104:107], v[48:63]
  ds_read_b128 v[104:107], v13 offset:30720
  buffer_store_dwordx4 v[148:151], v4, s[24:27], s42 offen sc1
  buffer_store_dwordx4 v[152:155], v4, s[24:27], s43 offen sc1
  v_mfma_f32_32x32x16_bf16 v[48:63], a[92:95], v[108:111], v[48:63]
  ds_read_b128 v[108:111], v13 offset:31744
  s_waitcnt lgkmcnt(4)
  v_mfma_f32_32x32x16_bf16 v[48:63], a[96:99], v[80:83], v[48:63]
  v_mfma_f32_32x32x16_bf16 v[48:63], a[100:103], v[84:87], v[48:63]
  v_mfma_f32_32x32x16_bf16 v[48:63], a[104:107], v[88:91], v[48:63]
  v_mfma_f32_32x32x16_bf16 v[48:63], a[108:111], v[92:95], v[48:63]
  s_waitcnt lgkmcnt(0)
  v_mfma_f32_32x32x16_bf16 v[48:63], a[112:115], v[96:99], v[48:63]
  v_mfma_f32_32x32x16_bf16 v[48:63], a[116:119], v[100:103], v[48:63]
  v_mfma_f32_32x32x16_bf16 v[48:63], a[120:123], v[104:107], v[48:63]
  v_mfma_f32_32x32x16_bf16 v[48:63], a[124:127], v[108:111], v[48:63]
  v_mfma_f32_32x32x16_bf16 v[48:63], v[144:147], v[120:123], v[48:63]
  s_nop 13
  v_pk_mul_f32 v[48:49], v[164:165], v[48:49]
  v_pk_mul_f32 v[50:51], v[166:167], v[50:51]
  v_pk_mul_f32 v[52:53], v[168:169], v[52:53]
  v_pk_mul_f32 v[54:55], v[170:171], v[54:55]
  v_pk_mul_f32 v[56:57], v[172:173], v[56:57]
  v_pk_mul_f32 v[58:59], v[174:175], v[58:59]
  v_pk_mul_f32 v[60:61], v[176:177], v[60:61]
  v_pk_mul_f32 v[62:63], v[178:179], v[62:63]
  v_cvt_pk_bf16_f32 v148, v48, v49
  v_cvt_pk_bf16_f32 v149, v50, v51
  v_cvt_pk_bf16_f32 v150, v52, v53
  v_cvt_pk_bf16_f32 v151, v54, v55
  v_cvt_pk_bf16_f32 v152, v56, v57
  v_cvt_pk_bf16_f32 v153, v58, v59
  v_cvt_pk_bf16_f32 v154, v60, v61
  v_cvt_pk_bf16_f32 v155, v62, v63
  buffer_store_dwordx4 v[148:151], v6, s[24:27], s44 offen sc1
  buffer_store_dwordx4 v[152:155], v6, s[24:27], s44 offen offset:512 sc1
qkv_kernel_exit:
  s_endpgm
.text
.globl attn_kernel
.p2align 8
.type attn_kernel,@function
attn_kernel:
  s_cmp_ge_u32 s2, 256
  s_cbranch_scc1 attn_kernel_exit
  s_load_dwordx2 s[4:5], s[0:1], 64
  v_lshrrev_b32 v1, 6, v0
  v_lshlrev_b32 v8, 4, v0
  v_and_b32 v0, 63, v0
  s_and_b32 s28, s2, 7
  v_readfirstlane_b32 s3, v1
  s_lshl_b32 s28, s28, 2
  s_bfe_u32 s29, s2, 0x20003
  s_add_u32 s28, s28, s29
  s_lshr_b32 s29, s2, 5
  s_lshl_b32 s29, s29, 3
  s_add_u32 s29, s29, s3
  v_lshlrev_b32 v4, 4, v0
  s_lshl_b32 s30, s28, 16
  s_lshl_b32 s31, s29, 10
  s_add_u32 s31, s31, s30
  s_waitcnt lgkmcnt(0)

  s_add_u32 s8, s4, 0xa80000
  s_addc_u32 s9, s5, 0
  s_mov_b32 s10, 0x600000
  s_mov_b32 s11, 0x20000
  buffer_load_dwordx4 v[100:103], v4, s[8:11], s31 offen
  s_lshl_b32 s32, s3, 11
  s_add_u32 s33, s30, 0x200000
  s_add_u32 s34, s33, s32
  s_mov_b32 m0, s32
  s_add_u32 s35, s34, 0x200000

  buffer_load_dwordx4 v4, s[8:11], s34 offen offset:0 lds
  buffer_load_dwordx4 v4, s[8:11], s34 offen offset:1024 lds
  s_add_u32 m0, s32, 65536
  s_mul_i32 s36, s3, 6144
  buffer_load_dwordx4 v4, s[8:11], s35 offen offset:0 lds
  buffer_load_dwordx4 v4, s[8:11], s35 offen offset:1024 lds
  s_add_u32 s36, s36, 16384
  s_add_u32 s34, s33, s36
  s_add_u32 s35, s34, 0x200000
  s_add_u32 m0, s36, 0
  s_nop 0
  buffer_load_dwordx4 v4, s[8:11], s34 offen offset:0 lds
  buffer_load_dwordx4 v4, s[8:11], s34 offen offset:1024 lds
  buffer_load_dwordx4 v4, s[8:11], s34 offen offset:2048 lds
  buffer_load_dwordx4 v4, s[8:11], s34 offen offset:3072 lds
  s_add_u32 m0, s36, 4096
  s_add_u32 s34, s34, 4096
  buffer_load_dwordx4 v4, s[8:11], s34 offen offset:0 lds
  buffer_load_dwordx4 v4, s[8:11], s34 offen offset:1024 lds
  s_add_u32 m0, s36, 65536
  s_nop 0
  buffer_load_dwordx4 v4, s[8:11], s35 offen offset:0 lds
  buffer_load_dwordx4 v4, s[8:11], s35 offen offset:1024 lds
  buffer_load_dwordx4 v4, s[8:11], s35 offen offset:2048 lds
  buffer_load_dwordx4 v4, s[8:11], s35 offen offset:3072 lds
  s_add_u32 m0, s36, 69632
  s_add_u32 s35, s35, 4096
  buffer_load_dwordx4 v4, s[8:11], s35 offen offset:0 lds
  buffer_load_dwordx4 v4, s[8:11], s35 offen offset:1024 lds
  v_lshrrev_b32 v13, 4, v8
  v_and_b32 v13, 27, v13
  v_cmp_eq_u32 vcc, 0, v13
  v_mov_b32 v12, 0x3f803f80
  v_mov_b32 v14, 0
  s_nop 0
  v_cndmask_b32 v12, v14, v12, vcc
  v_mov_b32 v13, v12
  v_mov_b32 v14, v12
  v_mov_b32 v15, v12
  v_add_u32 v8, 131072, v8
  ds_write_b128 v8, v[12:15]
  v_and_b32 v2, 31, v0
  v_lshrrev_b32 v3, 5, v0
  v_lshlrev_b32 v9, 8, v3
  v_lshl_add_u32 v9, v2, 4, v9
  v_add_u32 v9, 65536, v9
  v_subrev_u32 v10, 20, v2
  v_cmp_gt_u32 vcc, 8, v10
  v_mov_b32 v11, 131072
  v_mov_b32 v10, 131136
  v_cndmask_b32 v10, v11, v10, vcc
  v_and_b32 v11, 27, v2
  v_cmp_eq_u32 vcc, 16, v11
  v_add_u32 v11, 16, v10
  s_nop 0
  v_cndmask_b32 v10, v11, v10, vcc
  v_cmp_gt_u32 vcc, 16, v2
  v_mov_b32 v11, 4096
  s_nop 0
  v_cndmask_b32 v6, v10, v9, vcc
  v_cndmask_b32 v7, 0, v11, vcc
  v_mov_b32 v5, v6

  s_add_u32 s12, s4, 0x1080000
  s_addc_u32 s13, s5, 0
  s_mov_b32 s14, 0x200000
  s_mov_b32 s15, 0x20000
  s_lshl_b32 s38, s29, 15
  s_lshl_b32 s39, s28, 10
  s_add_u32 s38, s38, s39
  v_mov_b32 v64, 0
  v_mov_b32 v65, 0
  v_mov_b32 v66, 0
  v_mov_b32 v67, 0
  v_mov_b32 v68, 0
  v_mov_b32 v69, 0
  v_mov_b32 v70, 0
  v_mov_b32 v71, 0
  v_mov_b32 v72, 0
  v_mov_b32 v73, 0
  v_mov_b32 v74, 0
  v_mov_b32 v75, 0
  v_mov_b32 v76, 0
  v_mov_b32 v77, 0
  v_mov_b32 v78, 0
  v_mov_b32 v79, 0
  s_waitcnt vmcnt(12)
  s_waitcnt lgkmcnt(0)
  s_barrier
  ds_read_b128 v[80:83], v4 offset:0
  s_waitcnt lgkmcnt(0)
  v_mfma_f32_32x32x16_bf16 v[16:31], v[80:83], v[100:103], 0
  s_nop 12
  v_max3_f32 v8, v16, v17, v18
  v_max3_f32 v8, v8, v19, v20
  v_max3_f32 v8, v8, v21, v22
  v_max3_f32 v8, v8, v23, v24
  v_max3_f32 v8, v8, v25, v26
  v_max3_f32 v8, v8, v27, v28
  v_max3_f32 v8, v8, v29, v30
  v_max_f32 v8, v8, v31
  v_mov_b32 v9, v8
  s_nop 1
  v_permlane32_swap_b32 v8, v9
  s_nop 1
  v_max_f32 v8, v8, v9
  v_sub_f32 v48, 0, v8
  v_sub_f32 v49, 0, v8
  v_sub_f32 v50, 0, v8
  v_sub_f32 v51, 0, v8
  v_sub_f32 v52, 0, v8
  v_sub_f32 v53, 0, v8
  v_sub_f32 v54, 0, v8
  v_sub_f32 v55, 0, v8
  v_sub_f32 v56, 0, v8
  v_sub_f32 v57, 0, v8
  v_sub_f32 v58, 0, v8
  v_sub_f32 v59, 0, v8
  v_sub_f32 v60, 0, v8
  v_sub_f32 v61, 0, v8
  v_sub_f32 v62, 0, v8
  v_sub_f32 v63, 0, v8
  s_nop 1
  v_mfma_f32_32x32x16_bf16 v[16:31], v[80:83], v[100:103], v[48:63]
  ds_read_b128 v[80:83], v4 offset:1024
  ds_read_b128 v[84:87], v6 offset:0
  ds_read_b128 v[88:91], v6 offset:512
  s_nop 7
  s_cmp_ge_u32 s3, 4
  s_cbranch_scc1 attn_kernel_p0
  s_setprio 1
attn_kernel_p0:
  s_cbranch_scc0 attn_kernel_pr1
  s_setprio 2
attn_kernel_pr1:
  s_waitcnt lgkmcnt(2)
  v_mfma_f32_32x32x16_bf16 v[32:47], v[80:83], v[100:103], v[48:63]
  ds_read_b128 v[80:83], v4 offset:2048
  v_exp_f32 v16, v16
  v_exp_f32 v17, v17
  v_exp_f32 v18, v18
  v_exp_f32 v19, v19
  v_exp_f32 v20, v20
  v_exp_f32 v21, v21
  v_exp_f32 v22, v22
  v_exp_f32 v23, v23
  v_cvt_pk_bf16_f32 v92, v16, v17
  v_cvt_pk_bf16_f32 v93, v18, v19
  v_cvt_pk_bf16_f32 v94, v20, v21
  v_cvt_pk_bf16_f32 v95, v22, v23
  v_exp_f32 v24, v24
  v_exp_f32 v25, v25
  s_waitcnt lgkmcnt(2)
  v_mfma_f32_32x32x16_bf16 v[64:79], v[84:87], v[92:95], v[64:79]
  ds_read_b128 v[84:87], v6 offset:1024
  v_exp_f32 v26, v26
  v_exp_f32 v27, v27
  v_exp_f32 v28, v28
  v_exp_f32 v29, v29
  v_exp_f32 v30, v30
  v_exp_f32 v31, v31
  v_cvt_pk_bf16_f32 v96, v24, v25
  v_cvt_pk_bf16_f32 v97, v26, v27
  v_cvt_pk_bf16_f32 v98, v28, v29
  v_cvt_pk_bf16_f32 v99, v30, v31
  s_waitcnt lgkmcnt(2)
  s_nop 1
  v_mfma_f32_32x32x16_bf16 v[64:79], v[88:91], v[96:99], v[64:79]
  ds_read_b128 v[88:91], v6 offset:1536
  s_waitcnt lgkmcnt(2)
  v_mfma_f32_32x32x16_bf16 v[16:31], v[80:83], v[100:103], v[48:63]
  ds_read_b128 v[80:83], v4 offset:3072
  v_exp_f32 v32, v32
  v_exp_f32 v33, v33
  v_exp_f32 v34, v34
  v_exp_f32 v35, v35
  v_exp_f32 v36, v36
  v_exp_f32 v37, v37
  v_exp_f32 v38, v38
  v_exp_f32 v39, v39
  v_cvt_pk_bf16_f32 v92, v32, v33
  v_cvt_pk_bf16_f32 v93, v34, v35
  v_cvt_pk_bf16_f32 v94, v36, v37
  v_cvt_pk_bf16_f32 v95, v38, v39
  v_exp_f32 v40, v40
  v_exp_f32 v41, v41
  s_waitcnt lgkmcnt(2)
  v_mfma_f32_32x32x16_bf16 v[64:79], v[84:87], v[92:95], v[64:79]
  ds_read_b128 v[84:87], v6 offset:2048
  v_exp_f32 v42, v42
  v_exp_f32 v43, v43
  v_exp_f32 v44, v44
  v_exp_f32 v45, v45
  v_exp_f32 v46, v46
  v_exp_f32 v47, v47
  v_cvt_pk_bf16_f32 v96, v40, v41
  v_cvt_pk_bf16_f32 v97, v42, v43
  v_cvt_pk_bf16_f32 v98, v44, v45
  v_cvt_pk_bf16_f32 v99, v46, v47
  s_waitcnt lgkmcnt(2)
  s_nop 1
  v_mfma_f32_32x32x16_bf16 v[64:79], v[88:91], v[96:99], v[64:79]
  ds_read_b128 v[88:91], v6 offset:2560
  s_cbranch_scc0 attn_kernel_pr2
  s_setprio 0
attn_kernel_pr2:
  s_waitcnt lgkmcnt(2)
  v_mfma_f32_32x32x16_bf16 v[32:47], v[80:83], v[100:103], v[48:63]
  ds_read_b128 v[80:83], v4 offset:4096
  v_exp_f32 v16, v16
  v_exp_f32 v17, v17
  v_exp_f32 v18, v18
  v_exp_f32 v19, v19
  v_exp_f32 v20, v20
  v_exp_f32 v21, v21
  v_exp_f32 v22, v22
  v_exp_f32 v23, v23
  v_cvt_pk_bf16_f32 v92, v16, v17
  v_cvt_pk_bf16_f32 v93, v18, v19
  v_cvt_pk_bf16_f32 v94, v20, v21
  v_cvt_pk_bf16_f32 v95, v22, v23
  v_exp_f32 v24, v24
  v_exp_f32 v25, v25
  s_waitcnt lgkmcnt(2)
  v_mfma_f32_32x32x16_bf16 v[64:79], v[84:87], v[92:95], v[64:79]
  ds_read_b128 v[84:87], v6 offset:3072
  v_exp_f32 v26, v26
  v_exp_f32 v27, v27
  v_exp_f32 v28, v28
  v_exp_f32 v29, v29
  v_exp_f32 v30, v30
  v_exp_f32 v31, v31
  v_cvt_pk_bf16_f32 v96, v24, v25
  v_cvt_pk_bf16_f32 v97, v26, v27
  v_cvt_pk_bf16_f32 v98, v28, v29
  v_cvt_pk_bf16_f32 v99, v30, v31
  s_waitcnt lgkmcnt(2)
  s_nop 1
  v_mfma_f32_32x32x16_bf16 v[64:79], v[88:91], v[96:99], v[64:79]
  ds_read_b128 v[88:91], v6 offset:3584
  s_cbranch_scc0 attn_kernel_pr3
  s_setprio 2
attn_kernel_pr3:
  s_waitcnt lgkmcnt(2)
  v_mfma_f32_32x32x16_bf16 v[16:31], v[80:83], v[100:103], v[48:63]
  ds_read_b128 v[80:83], v4 offset:5120
  v_exp_f32 v32, v32
  v_exp_f32 v33, v33
  v_exp_f32 v34, v34
  v_exp_f32 v35, v35
  v_exp_f32 v36, v36
  v_exp_f32 v37, v37
  v_exp_f32 v38, v38
  v_exp_f32 v39, v39
  v_cvt_pk_bf16_f32 v92, v32, v33
  v_cvt_pk_bf16_f32 v93, v34, v35
  v_cvt_pk_bf16_f32 v94, v36, v37
  v_cvt_pk_bf16_f32 v95, v38, v39
  v_exp_f32 v40, v40
  v_exp_f32 v41, v41
  s_waitcnt lgkmcnt(2)
  v_mfma_f32_32x32x16_bf16 v[64:79], v[84:87], v[92:95], v[64:79]
  v_add_u32 v6, v7, v6
  ds_read_b128 v[84:87], v6 offset:0
  v_exp_f32 v42, v42
  v_exp_f32 v43, v43
  v_exp_f32 v44, v44
  v_exp_f32 v45, v45
  v_exp_f32 v46, v46
  v_exp_f32 v47, v47
  v_cvt_pk_bf16_f32 v96, v40, v41
  v_cvt_pk_bf16_f32 v97, v42, v43
  v_cvt_pk_bf16_f32 v98, v44, v45
  v_cvt_pk_bf16_f32 v99, v46, v47
  s_waitcnt lgkmcnt(2)
  s_nop 1
  v_mfma_f32_32x32x16_bf16 v[64:79], v[88:91], v[96:99], v[64:79]
  ds_read_b128 v[88:91], v6 offset:512
  s_waitcnt lgkmcnt(2)
  v_mfma_f32_32x32x16_bf16 v[32:47], v[80:83], v[100:103], v[48:63]
  ds_read_b128 v[80:83], v4 offset:6144
  v_exp_f32 v16, v16
  v_exp_f32 v17, v17
  v_exp_f32 v18, v18
  v_exp_f32 v19, v19
  v_exp_f32 v20, v20
  v_exp_f32 v21, v21
  v_exp_f32 v22, v22
  v_exp_f32 v23, v23
  v_cvt_pk_bf16_f32 v92, v16, v17
  v_cvt_pk_bf16_f32 v93, v18, v19
  v_cvt_pk_bf16_f32 v94, v20, v21
  v_cvt_pk_bf16_f32 v95, v22, v23
  v_exp_f32 v24, v24
  v_exp_f32 v25, v25
  s_waitcnt lgkmcnt(2)
  v_mfma_f32_32x32x16_bf16 v[64:79], v[84:87], v[92:95], v[64:79]
  ds_read_b128 v[84:87], v6 offset:1024
  v_exp_f32 v26, v26
  v_exp_f32 v27, v27
  v_exp_f32 v28, v28
  v_exp_f32 v29, v29
  v_exp_f32 v30, v30
  v_exp_f32 v31, v31
  v_cvt_pk_bf16_f32 v96, v24, v25
  v_cvt_pk_bf16_f32 v97, v26, v27
  v_cvt_pk_bf16_f32 v98, v28, v29
  v_cvt_pk_bf16_f32 v99, v30, v31
  s_waitcnt lgkmcnt(2)
  s_nop 1
  v_mfma_f32_32x32x16_bf16 v[64:79], v[88:91], v[96:99], v[64:79]
  ds_read_b128 v[88:91], v6 offset:1536
  s_cbranch_scc0 attn_kernel_pr4
  s_setprio 0
attn_kernel_pr4:
  s_waitcnt lgkmcnt(2)
  v_mfma_f32_32x32x16_bf16 v[16:31], v[80:83], v[100:103], v[48:63]
  ds_read_b128 v[80:83], v4 offset:7168
  v_exp_f32 v32, v32
  v_exp_f32 v33, v33
  v_exp_f32 v34, v34
  v_exp_f32 v35, v35
  v_exp_f32 v36, v36
  v_exp_f32 v37, v37
  v_exp_f32 v38, v38
  v_exp_f32 v39, v39
  v_cvt_pk_bf16_f32 v92, v32, v33
  v_cvt_pk_bf16_f32 v93, v34, v35
  v_cvt_pk_bf16_f32 v94, v36, v37
  v_cvt_pk_bf16_f32 v95, v38, v39
  v_exp_f32 v40, v40
  v_exp_f32 v41, v41
  s_waitcnt lgkmcnt(2)
  v_mfma_f32_32x32x16_bf16 v[64:79], v[84:87], v[92:95], v[64:79]
  ds_read_b128 v[84:87], v6 offset:2048
  v_exp_f32 v42, v42
  v_exp_f32 v43, v43
  v_exp_f32 v44, v44
  v_exp_f32 v45, v45
  v_exp_f32 v46, v46
  v_exp_f32 v47, v47
  v_cvt_pk_bf16_f32 v96, v40, v41
  v_cvt_pk_bf16_f32 v97, v42, v43
  v_cvt_pk_bf16_f32 v98, v44, v45
  v_cvt_pk_bf16_f32 v99, v46, v47
  s_waitcnt lgkmcnt(2)
  s_nop 1
  v_mfma_f32_32x32x16_bf16 v[64:79], v[88:91], v[96:99], v[64:79]
  ds_read_b128 v[88:91], v6 offset:2560
  s_cbranch_scc0 attn_kernel_pr5
  s_setprio 2
attn_kernel_pr5:
  s_waitcnt lgkmcnt(2)
  v_mfma_f32_32x32x16_bf16 v[32:47], v[80:83], v[100:103], v[48:63]
  ds_read_b128 v[80:83], v4 offset:8192
  v_exp_f32 v16, v16
  v_exp_f32 v17, v17
  v_exp_f32 v18, v18
  v_exp_f32 v19, v19
  v_exp_f32 v20, v20
  v_exp_f32 v21, v21
  v_exp_f32 v22, v22
  v_exp_f32 v23, v23
  v_cvt_pk_bf16_f32 v92, v16, v17
  v_cvt_pk_bf16_f32 v93, v18, v19
  v_cvt_pk_bf16_f32 v94, v20, v21
  v_cvt_pk_bf16_f32 v95, v22, v23
  v_exp_f32 v24, v24
  v_exp_f32 v25, v25
  s_waitcnt lgkmcnt(2)
  v_mfma_f32_32x32x16_bf16 v[64:79], v[84:87], v[92:95], v[64:79]
  ds_read_b128 v[84:87], v6 offset:3072
  v_exp_f32 v26, v26
  v_exp_f32 v27, v27
  v_exp_f32 v28, v28
  v_exp_f32 v29, v29
  v_exp_f32 v30, v30
  v_exp_f32 v31, v31
  v_cvt_pk_bf16_f32 v96, v24, v25
  v_cvt_pk_bf16_f32 v97, v26, v27
  v_cvt_pk_bf16_f32 v98, v28, v29
  v_cvt_pk_bf16_f32 v99, v30, v31
  s_waitcnt lgkmcnt(2)
  s_nop 1
  v_mfma_f32_32x32x16_bf16 v[64:79], v[88:91], v[96:99], v[64:79]
  ds_read_b128 v[88:91], v6 offset:3584
  s_waitcnt lgkmcnt(2)
  v_mfma_f32_32x32x16_bf16 v[16:31], v[80:83], v[100:103], v[48:63]
  ds_read_b128 v[80:83], v4 offset:9216
  v_exp_f32 v32, v32
  v_exp_f32 v33, v33
  v_exp_f32 v34, v34
  v_exp_f32 v35, v35
  v_exp_f32 v36, v36
  v_exp_f32 v37, v37
  v_exp_f32 v38, v38
  v_exp_f32 v39, v39
  v_cvt_pk_bf16_f32 v92, v32, v33
  v_cvt_pk_bf16_f32 v93, v34, v35
  v_cvt_pk_bf16_f32 v94, v36, v37
  v_cvt_pk_bf16_f32 v95, v38, v39
  v_exp_f32 v40, v40
  v_exp_f32 v41, v41
  s_waitcnt lgkmcnt(2)
  v_mfma_f32_32x32x16_bf16 v[64:79], v[84:87], v[92:95], v[64:79]
  v_add_u32 v6, v7, v6
  ds_read_b128 v[84:87], v6 offset:0
  v_exp_f32 v42, v42
  v_exp_f32 v43, v43
  v_exp_f32 v44, v44
  v_exp_f32 v45, v45
  v_exp_f32 v46, v46
  v_exp_f32 v47, v47
  v_cvt_pk_bf16_f32 v96, v40, v41
  v_cvt_pk_bf16_f32 v97, v42, v43
  v_cvt_pk_bf16_f32 v98, v44, v45
  v_cvt_pk_bf16_f32 v99, v46, v47
  s_waitcnt lgkmcnt(2)
  s_nop 1
  v_mfma_f32_32x32x16_bf16 v[64:79], v[88:91], v[96:99], v[64:79]
  ds_read_b128 v[88:91], v6 offset:512
  s_cbranch_scc0 attn_kernel_pr6
  s_setprio 0
attn_kernel_pr6:
  s_waitcnt lgkmcnt(2)
  v_mfma_f32_32x32x16_bf16 v[32:47], v[80:83], v[100:103], v[48:63]
  ds_read_b128 v[80:83], v4 offset:10240
  v_exp_f32 v16, v16
  v_exp_f32 v17, v17
  v_exp_f32 v18, v18
  v_exp_f32 v19, v19
  v_exp_f32 v20, v20
  v_exp_f32 v21, v21
  v_exp_f32 v22, v22
  v_exp_f32 v23, v23
  v_cvt_pk_bf16_f32 v92, v16, v17
  v_cvt_pk_bf16_f32 v93, v18, v19
  v_cvt_pk_bf16_f32 v94, v20, v21
  v_cvt_pk_bf16_f32 v95, v22, v23
  v_exp_f32 v24, v24
  v_exp_f32 v25, v25
  s_waitcnt lgkmcnt(2)
  v_mfma_f32_32x32x16_bf16 v[64:79], v[84:87], v[92:95], v[64:79]
  ds_read_b128 v[84:87], v6 offset:1024
  v_exp_f32 v26, v26
  v_exp_f32 v27, v27
  v_exp_f32 v28, v28
  v_exp_f32 v29, v29
  v_exp_f32 v30, v30
  v_exp_f32 v31, v31
  v_cvt_pk_bf16_f32 v96, v24, v25
  v_cvt_pk_bf16_f32 v97, v26, v27
  v_cvt_pk_bf16_f32 v98, v28, v29
  v_cvt_pk_bf16_f32 v99, v30, v31
  s_waitcnt lgkmcnt(2)
  s_nop 1
  v_mfma_f32_32x32x16_bf16 v[64:79], v[88:91], v[96:99], v[64:79]
  ds_read_b128 v[88:91], v6 offset:1536
  s_cbranch_scc0 attn_kernel_pr7
  s_setprio 2
attn_kernel_pr7:
  s_waitcnt lgkmcnt(2)
  v_mfma_f32_32x32x16_bf16 v[16:31], v[80:83], v[100:103], v[48:63]
  ds_read_b128 v[80:83], v4 offset:11264
  v_exp_f32 v32, v32
  v_exp_f32 v33, v33
  v_exp_f32 v34, v34
  v_exp_f32 v35, v35
  v_exp_f32 v36, v36
  v_exp_f32 v37, v37
  v_exp_f32 v38, v38
  v_exp_f32 v39, v39
  v_cvt_pk_bf16_f32 v92, v32, v33
  v_cvt_pk_bf16_f32 v93, v34, v35
  v_cvt_pk_bf16_f32 v94, v36, v37
  v_cvt_pk_bf16_f32 v95, v38, v39
  v_exp_f32 v40, v40
  v_exp_f32 v41, v41
  s_waitcnt lgkmcnt(2)
  v_mfma_f32_32x32x16_bf16 v[64:79], v[84:87], v[92:95], v[64:79]
  ds_read_b128 v[84:87], v6 offset:2048
  v_exp_f32 v42, v42
  v_exp_f32 v43, v43
  v_exp_f32 v44, v44
  v_exp_f32 v45, v45
  v_exp_f32 v46, v46
  v_exp_f32 v47, v47
  v_cvt_pk_bf16_f32 v96, v40, v41
  v_cvt_pk_bf16_f32 v97, v42, v43
  v_cvt_pk_bf16_f32 v98, v44, v45
  v_cvt_pk_bf16_f32 v99, v46, v47
  s_waitcnt lgkmcnt(2)
  s_nop 1
  v_mfma_f32_32x32x16_bf16 v[64:79], v[88:91], v[96:99], v[64:79]
  ds_read_b128 v[88:91], v6 offset:2560
  s_waitcnt lgkmcnt(2)
  v_mfma_f32_32x32x16_bf16 v[32:47], v[80:83], v[100:103], v[48:63]
  ds_read_b128 v[80:83], v4 offset:12288
  v_exp_f32 v16, v16
  v_exp_f32 v17, v17
  v_exp_f32 v18, v18
  v_exp_f32 v19, v19
  v_exp_f32 v20, v20
  v_exp_f32 v21, v21
  v_exp_f32 v22, v22
  v_exp_f32 v23, v23
  v_cvt_pk_bf16_f32 v92, v16, v17
  v_cvt_pk_bf16_f32 v93, v18, v19
  v_cvt_pk_bf16_f32 v94, v20, v21
  v_cvt_pk_bf16_f32 v95, v22, v23
  v_exp_f32 v24, v24
  v_exp_f32 v25, v25
  s_waitcnt lgkmcnt(2)
  v_mfma_f32_32x32x16_bf16 v[64:79], v[84:87], v[92:95], v[64:79]
  ds_read_b128 v[84:87], v6 offset:3072
  v_exp_f32 v26, v26
  v_exp_f32 v27, v27
  v_exp_f32 v28, v28
  v_exp_f32 v29, v29
  v_exp_f32 v30, v30
  v_exp_f32 v31, v31
  v_cvt_pk_bf16_f32 v96, v24, v25
  v_cvt_pk_bf16_f32 v97, v26, v27
  v_cvt_pk_bf16_f32 v98, v28, v29
  v_cvt_pk_bf16_f32 v99, v30, v31
  s_waitcnt lgkmcnt(2)
  s_nop 1
  v_mfma_f32_32x32x16_bf16 v[64:79], v[88:91], v[96:99], v[64:79]
  ds_read_b128 v[88:91], v6 offset:3584
  s_cbranch_scc0 attn_kernel_pr8
  s_setprio 0
attn_kernel_pr8:
  s_waitcnt lgkmcnt(2)
  v_mfma_f32_32x32x16_bf16 v[16:31], v[80:83], v[100:103], v[48:63]
  ds_read_b128 v[80:83], v4 offset:13312
  v_exp_f32 v32, v32
  v_exp_f32 v33, v33
  v_exp_f32 v34, v34
  v_exp_f32 v35, v35
  v_exp_f32 v36, v36
  v_exp_f32 v37, v37
  v_exp_f32 v38, v38
  v_exp_f32 v39, v39
  v_cvt_pk_bf16_f32 v92, v32, v33
  v_cvt_pk_bf16_f32 v93, v34, v35
  v_cvt_pk_bf16_f32 v94, v36, v37
  v_cvt_pk_bf16_f32 v95, v38, v39
  v_exp_f32 v40, v40
  v_exp_f32 v41, v41
  s_waitcnt lgkmcnt(2)
  v_mfma_f32_32x32x16_bf16 v[64:79], v[84:87], v[92:95], v[64:79]
  v_add_u32 v6, v7, v6
  ds_read_b128 v[84:87], v6 offset:0
  v_exp_f32 v42, v42
  v_exp_f32 v43, v43
  v_exp_f32 v44, v44
  v_exp_f32 v45, v45
  v_exp_f32 v46, v46
  v_exp_f32 v47, v47
  v_cvt_pk_bf16_f32 v96, v40, v41
  v_cvt_pk_bf16_f32 v97, v42, v43
  v_cvt_pk_bf16_f32 v98, v44, v45
  v_cvt_pk_bf16_f32 v99, v46, v47
  s_waitcnt lgkmcnt(2)
  s_nop 1
  v_mfma_f32_32x32x16_bf16 v[64:79], v[88:91], v[96:99], v[64:79]
  ds_read_b128 v[88:91], v6 offset:512
  s_cbranch_scc0 attn_kernel_pr9
  s_setprio 2
attn_kernel_pr9:
  s_waitcnt lgkmcnt(2)
  v_mfma_f32_32x32x16_bf16 v[32:47], v[80:83], v[100:103], v[48:63]
  ds_read_b128 v[80:83], v4 offset:14336
  v_exp_f32 v16, v16
  v_exp_f32 v17, v17
  v_exp_f32 v18, v18
  v_exp_f32 v19, v19
  v_exp_f32 v20, v20
  v_exp_f32 v21, v21
  v_exp_f32 v22, v22
  v_exp_f32 v23, v23
  v_cvt_pk_bf16_f32 v92, v16, v17
  v_cvt_pk_bf16_f32 v93, v18, v19
  v_cvt_pk_bf16_f32 v94, v20, v21
  v_cvt_pk_bf16_f32 v95, v22, v23
  v_exp_f32 v24, v24
  v_exp_f32 v25, v25
  s_waitcnt lgkmcnt(2)
  v_mfma_f32_32x32x16_bf16 v[64:79], v[84:87], v[92:95], v[64:79]
  ds_read_b128 v[84:87], v6 offset:1024
  v_exp_f32 v26, v26
  v_exp_f32 v27, v27
  v_exp_f32 v28, v28
  v_exp_f32 v29, v29
  v_exp_f32 v30, v30
  v_exp_f32 v31, v31
  v_cvt_pk_bf16_f32 v96, v24, v25
  v_cvt_pk_bf16_f32 v97, v26, v27
  v_cvt_pk_bf16_f32 v98, v28, v29
  v_cvt_pk_bf16_f32 v99, v30, v31
  s_waitcnt lgkmcnt(2)
  s_nop 1
  v_mfma_f32_32x32x16_bf16 v[64:79], v[88:91], v[96:99], v[64:79]
  ds_read_b128 v[88:91], v6 offset:1536
  s_waitcnt vmcnt(0)
  s_barrier
  s_add_u32 s16, s4, 0x190000
  s_addc_u32 s17, s5, 0
  s_mov_b32 s18, 0x250000
  s_mov_b32 s19, 0x20000
  s_lshr_b32 s41, s2, 3
  s_sub_u32 s41, s41, 0
  s_mul_i32 s41, s41, 8
  s_add_u32 s41, s41, s3
  s_mul_i32 s41, s41, 8192
  v_mul_u32_u24 v104, 128, v0
  v_add_u32 v104, s41, v104
  s_mov_b32 s41, 0x0
  buffer_load_dword v105, v104, s[16:19], s41 offen
  s_mov_b32 s41, 0x200000
  buffer_load_dword v105, v104, s[16:19], s41 offen
  s_cmp_ge_u32 s3, 4
  s_waitcnt lgkmcnt(2)
  v_mfma_f32_32x32x16_bf16 v[16:31], v[80:83], v[100:103], v[48:63]
  ds_read_b128 v[80:83], v4 offset:15360
  v_exp_f32 v32, v32
  v_exp_f32 v33, v33
  v_exp_f32 v34, v34
  v_exp_f32 v35, v35
  v_exp_f32 v36, v36
  v_exp_f32 v37, v37
  v_exp_f32 v38, v38
  v_exp_f32 v39, v39
  v_cvt_pk_bf16_f32 v92, v32, v33
  v_cvt_pk_bf16_f32 v93, v34, v35
  v_cvt_pk_bf16_f32 v94, v36, v37
  v_cvt_pk_bf16_f32 v95, v38, v39
  v_exp_f32 v40, v40
  v_exp_f32 v41, v41
  s_waitcnt lgkmcnt(2)
  v_mfma_f32_32x32x16_bf16 v[64:79], v[84:87], v[92:95], v[64:79]
  ds_read_b128 v[84:87], v6 offset:2048
  v_exp_f32 v42, v42
  v_exp_f32 v43, v43
  v_exp_f32 v44, v44
  v_exp_f32 v45, v45
  v_exp_f32 v46, v46
  v_exp_f32 v47, v47
  v_cvt_pk_bf16_f32 v96, v40, v41
  v_cvt_pk_bf16_f32 v97, v42, v43
  v_cvt_pk_bf16_f32 v98, v44, v45
  v_cvt_pk_bf16_f32 v99, v46, v47
  s_waitcnt lgkmcnt(2)
  s_nop 1
  v_mfma_f32_32x32x16_bf16 v[64:79], v[88:91], v[96:99], v[64:79]
  ds_read_b128 v[88:91], v6 offset:2560
  s_cbranch_scc0 attn_kernel_pr10
  s_setprio 0
attn_kernel_pr10:
  s_waitcnt lgkmcnt(2)
  v_mfma_f32_32x32x16_bf16 v[32:47], v[80:83], v[100:103], v[48:63]
  ds_read_b128 v[80:83], v4 offset:16384
  v_exp_f32 v16, v16
  v_exp_f32 v17, v17
  v_exp_f32 v18, v18
  v_exp_f32 v19, v19
  v_exp_f32 v20, v20
  v_exp_f32 v21, v21
  v_exp_f32 v22, v22
  v_exp_f32 v23, v23
  v_cvt_pk_bf16_f32 v92, v16, v17
  v_cvt_pk_bf16_f32 v93, v18, v19
  v_cvt_pk_bf16_f32 v94, v20, v21
  v_cvt_pk_bf16_f32 v95, v22, v23
  v_exp_f32 v24, v24
  v_exp_f32 v25, v25
  s_waitcnt lgkmcnt(2)
  v_mfma_f32_32x32x16_bf16 v[64:79], v[84:87], v[92:95], v[64:79]
  ds_read_b128 v[84:87], v6 offset:3072
  v_exp_f32 v26, v26
  v_exp_f32 v27, v27
  v_exp_f32 v28, v28
  v_exp_f32 v29, v29
  v_exp_f32 v30, v30
  v_exp_f32 v31, v31
  v_cvt_pk_bf16_f32 v96, v24, v25
  v_cvt_pk_bf16_f32 v97, v26, v27
  v_cvt_pk_bf16_f32 v98, v28, v29
  v_cvt_pk_bf16_f32 v99, v30, v31
  s_waitcnt lgkmcnt(2)
  s_nop 1
  v_mfma_f32_32x32x16_bf16 v[64:79], v[88:91], v[96:99], v[64:79]
  ds_read_b128 v[88:91], v6 offset:3584
  s_cbranch_scc0 attn_kernel_pr11
  s_setprio 2
attn_kernel_pr11:
  s_waitcnt lgkmcnt(2)
  v_mfma_f32_32x32x16_bf16 v[16:31], v[80:83], v[100:103], v[48:63]
  ds_read_b128 v[80:83], v4 offset:17408
  v_exp_f32 v32, v32
  v_exp_f32 v33, v33
  v_exp_f32 v34, v34
  v_exp_f32 v35, v35
  v_exp_f32 v36, v36
  v_exp_f32 v37, v37
  v_exp_f32 v38, v38
  v_exp_f32 v39, v39
  v_cvt_pk_bf16_f32 v92, v32, v33
  v_cvt_pk_bf16_f32 v93, v34, v35
  v_cvt_pk_bf16_f32 v94, v36, v37
  v_cvt_pk_bf16_f32 v95, v38, v39
  v_exp_f32 v40, v40
  v_exp_f32 v41, v41
  s_waitcnt lgkmcnt(2)
  v_mfma_f32_32x32x16_bf16 v[64:79], v[84:87], v[92:95], v[64:79]
  v_add_u32 v6, v7, v6
  ds_read_b128 v[84:87], v6 offset:0
  v_exp_f32 v42, v42
  v_exp_f32 v43, v43
  v_exp_f32 v44, v44
  v_exp_f32 v45, v45
  v_exp_f32 v46, v46
  v_exp_f32 v47, v47
  v_cvt_pk_bf16_f32 v96, v40, v41
  v_cvt_pk_bf16_f32 v97, v42, v43
  v_cvt_pk_bf16_f32 v98, v44, v45
  v_cvt_pk_bf16_f32 v99, v46, v47
  s_waitcnt lgkmcnt(2)
  s_nop 1
  v_mfma_f32_32x32x16_bf16 v[64:79], v[88:91], v[96:99], v[64:79]
  ds_read_b128 v[88:91], v6 offset:512
  s_waitcnt lgkmcnt(2)
  v_mfma_f32_32x32x16_bf16 v[32:47], v[80:83], v[100:103], v[48:63]
  ds_read_b128 v[80:83], v4 offset:18432
  v_exp_f32 v16, v16
  v_exp_f32 v17, v17
  v_exp_f32 v18, v18
  v_exp_f32 v19, v19
  v_exp_f32 v20, v20
  v_exp_f32 v21, v21
  v_exp_f32 v22, v22
  v_exp_f32 v23, v23
  v_cvt_pk_bf16_f32 v92, v16, v17
  v_cvt_pk_bf16_f32 v93, v18, v19
  v_cvt_pk_bf16_f32 v94, v20, v21
  v_cvt_pk_bf16_f32 v95, v22, v23
  v_exp_f32 v24, v24
  v_exp_f32 v25, v25
  s_waitcnt lgkmcnt(2)
  v_mfma_f32_32x32x16_bf16 v[64:79], v[84:87], v[92:95], v[64:79]
  ds_read_b128 v[84:87], v6 offset:1024
  v_exp_f32 v26, v26
  v_exp_f32 v27, v27
  v_exp_f32 v28, v28
  v_exp_f32 v29, v29
  v_exp_f32 v30, v30
  v_exp_f32 v31, v31
  v_cvt_pk_bf16_f32 v96, v24, v25
  v_cvt_pk_bf16_f32 v97, v26, v27
  v_cvt_pk_bf16_f32 v98, v28, v29
  v_cvt_pk_bf16_f32 v99, v30, v31
  s_waitcnt lgkmcnt(2)
  s_nop 1
  v_mfma_f32_32x32x16_bf16 v[64:79], v[88:91], v[96:99], v[64:79]
  ds_read_b128 v[88:91], v6 offset:1536
  s_cbranch_scc0 attn_kernel_pr12
  s_setprio 0
attn_kernel_pr12:
  s_waitcnt lgkmcnt(2)
  v_mfma_f32_32x32x16_bf16 v[16:31], v[80:83], v[100:103], v[48:63]
  ds_read_b128 v[80:83], v4 offset:19456
  v_exp_f32 v32, v32
  v_exp_f32 v33, v33
  v_exp_f32 v34, v34
  v_exp_f32 v35, v35
  v_exp_f32 v36, v36
  v_exp_f32 v37, v37
  v_exp_f32 v38, v38
  v_exp_f32 v39, v39
  v_cvt_pk_bf16_f32 v92, v32, v33
  v_cvt_pk_bf16_f32 v93, v34, v35
  v_cvt_pk_bf16_f32 v94, v36, v37
  v_cvt_pk_bf16_f32 v95, v38, v39
  v_exp_f32 v40, v40
  v_exp_f32 v41, v41
  s_waitcnt lgkmcnt(2)
  v_mfma_f32_32x32x16_bf16 v[64:79], v[84:87], v[92:95], v[64:79]
  ds_read_b128 v[84:87], v6 offset:2048
  v_exp_f32 v42, v42
  v_exp_f32 v43, v43
  v_exp_f32 v44, v44
  v_exp_f32 v45, v45
  v_exp_f32 v46, v46
  v_exp_f32 v47, v47
  v_cvt_pk_bf16_f32 v96, v40, v41
  v_cvt_pk_bf16_f32 v97, v42, v43
  v_cvt_pk_bf16_f32 v98, v44, v45
  v_cvt_pk_bf16_f32 v99, v46, v47
  s_waitcnt lgkmcnt(2)
  s_nop 1
  v_mfma_f32_32x32x16_bf16 v[64:79], v[88:91], v[96:99], v[64:79]
  ds_read_b128 v[88:91], v6 offset:2560
  s_cbranch_scc0 attn_kernel_pr13
  s_setprio 2
attn_kernel_pr13:
  s_waitcnt lgkmcnt(2)
  v_mfma_f32_32x32x16_bf16 v[32:47], v[80:83], v[100:103], v[48:63]
  ds_read_b128 v[80:83], v4 offset:20480
  v_exp_f32 v16, v16
  v_exp_f32 v17, v17
  v_exp_f32 v18, v18
  v_exp_f32 v19, v19
  v_exp_f32 v20, v20
  v_exp_f32 v21, v21
  v_exp_f32 v22, v22
  v_exp_f32 v23, v23
  v_cvt_pk_bf16_f32 v92, v16, v17
  v_cvt_pk_bf16_f32 v93, v18, v19
  v_cvt_pk_bf16_f32 v94, v20, v21
  v_cvt_pk_bf16_f32 v95, v22, v23
  v_exp_f32 v24, v24
  v_exp_f32 v25, v25
  s_waitcnt lgkmcnt(2)
  v_mfma_f32_32x32x16_bf16 v[64:79], v[84:87], v[92:95], v[64:79]
  ds_read_b128 v[84:87], v6 offset:3072
  v_exp_f32 v26, v26
  v_exp_f32 v27, v27
  v_exp_f32 v28, v28
  v_exp_f32 v29, v29
  v_exp_f32 v30, v30
  v_exp_f32 v31, v31
  v_cvt_pk_bf16_f32 v96, v24, v25
  v_cvt_pk_bf16_f32 v97, v26, v27
  v_cvt_pk_bf16_f32 v98, v28, v29
  v_cvt_pk_bf16_f32 v99, v30, v31
  s_waitcnt lgkmcnt(2)
  s_nop 1
  v_mfma_f32_32x32x16_bf16 v[64:79], v[88:91], v[96:99], v[64:79]
  ds_read_b128 v[88:91], v6 offset:3584
  s_waitcnt lgkmcnt(2)
  v_mfma_f32_32x32x16_bf16 v[16:31], v[80:83], v[100:103], v[48:63]
  ds_read_b128 v[80:83], v4 offset:21504
  v_exp_f32 v32, v32
  v_exp_f32 v33, v33
  v_exp_f32 v34, v34
  v_exp_f32 v35, v35
  v_exp_f32 v36, v36
  v_exp_f32 v37, v37
  v_exp_f32 v38, v38
  v_exp_f32 v39, v39
  v_cvt_pk_bf16_f32 v92, v32, v33
  v_cvt_pk_bf16_f32 v93, v34, v35
  v_cvt_pk_bf16_f32 v94, v36, v37
  v_cvt_pk_bf16_f32 v95, v38, v39
  v_exp_f32 v40, v40
  v_exp_f32 v41, v41
  s_waitcnt lgkmcnt(2)
  v_mfma_f32_32x32x16_bf16 v[64:79], v[84:87], v[92:95], v[64:79]
  v_add_u32 v6, v7, v6
  ds_read_b128 v[84:87], v6 offset:0
  v_exp_f32 v42, v42
  v_exp_f32 v43, v43
  v_exp_f32 v44, v44
  v_exp_f32 v45, v45
  v_exp_f32 v46, v46
  v_exp_f32 v47, v47
  v_cvt_pk_bf16_f32 v96, v40, v41
  v_cvt_pk_bf16_f32 v97, v42, v43
  v_cvt_pk_bf16_f32 v98, v44, v45
  v_cvt_pk_bf16_f32 v99, v46, v47
  s_waitcnt lgkmcnt(2)
  s_nop 1
  v_mfma_f32_32x32x16_bf16 v[64:79], v[88:91], v[96:99], v[64:79]
  ds_read_b128 v[88:91], v6 offset:512
  s_cbranch_scc0 attn_kernel_pr14
  s_setprio 0
attn_kernel_pr14:
  s_waitcnt lgkmcnt(2)
  v_mfma_f32_32x32x16_bf16 v[32:47], v[80:83], v[100:103], v[48:63]
  ds_read_b128 v[80:83], v4 offset:22528
  v_exp_f32 v16, v16
  v_exp_f32 v17, v17
  v_exp_f32 v18, v18
  v_exp_f32 v19, v19
  v_exp_f32 v20, v20
  v_exp_f32 v21, v21
  v_exp_f32 v22, v22
  v_exp_f32 v23, v23
  v_cvt_pk_bf16_f32 v92, v16, v17
  v_cvt_pk_bf16_f32 v93, v18, v19
  v_cvt_pk_bf16_f32 v94, v20, v21
  v_cvt_pk_bf16_f32 v95, v22, v23
  v_exp_f32 v24, v24
  v_exp_f32 v25, v25
  s_waitcnt lgkmcnt(2)
  v_mfma_f32_32x32x16_bf16 v[64:79], v[84:87], v[92:95], v[64:79]
  ds_read_b128 v[84:87], v6 offset:1024
  v_exp_f32 v26, v26
  v_exp_f32 v27, v27
  v_exp_f32 v28, v28
  v_exp_f32 v29, v29
  v_exp_f32 v30, v30
  v_exp_f32 v31, v31
  v_cvt_pk_bf16_f32 v96, v24, v25
  v_cvt_pk_bf16_f32 v97, v26, v27
  v_cvt_pk_bf16_f32 v98, v28, v29
  v_cvt_pk_bf16_f32 v99, v30, v31
  s_waitcnt lgkmcnt(2)
  s_nop 1
  v_mfma_f32_32x32x16_bf16 v[64:79], v[88:91], v[96:99], v[64:79]
  ds_read_b128 v[88:91], v6 offset:1536
  s_cbranch_scc0 attn_kernel_pr15
  s_setprio 2
attn_kernel_pr15:
  s_waitcnt lgkmcnt(2)
  v_mfma_f32_32x32x16_bf16 v[16:31], v[80:83], v[100:103], v[48:63]
  ds_read_b128 v[80:83], v4 offset:23552
  v_exp_f32 v32, v32
  v_exp_f32 v33, v33
  v_exp_f32 v34, v34
  v_exp_f32 v35, v35
  v_exp_f32 v36, v36
  v_exp_f32 v37, v37
  v_exp_f32 v38, v38
  v_exp_f32 v39, v39
  v_cvt_pk_bf16_f32 v92, v32, v33
  v_cvt_pk_bf16_f32 v93, v34, v35
  v_cvt_pk_bf16_f32 v94, v36, v37
  v_cvt_pk_bf16_f32 v95, v38, v39
  v_exp_f32 v40, v40
  v_exp_f32 v41, v41
  s_waitcnt lgkmcnt(2)
  v_mfma_f32_32x32x16_bf16 v[64:79], v[84:87], v[92:95], v[64:79]
  ds_read_b128 v[84:87], v6 offset:2048
  v_exp_f32 v42, v42
  v_exp_f32 v43, v43
  v_exp_f32 v44, v44
  v_exp_f32 v45, v45
  v_exp_f32 v46, v46
  v_exp_f32 v47, v47
  v_cvt_pk_bf16_f32 v96, v40, v41
  v_cvt_pk_bf16_f32 v97, v42, v43
  v_cvt_pk_bf16_f32 v98, v44, v45
  v_cvt_pk_bf16_f32 v99, v46, v47
  s_waitcnt lgkmcnt(2)
  s_nop 1
  v_mfma_f32_32x32x16_bf16 v[64:79], v[88:91], v[96:99], v[64:79]
  ds_read_b128 v[88:91], v6 offset:2560
  s_waitcnt lgkmcnt(2)
  v_mfma_f32_32x32x16_bf16 v[32:47], v[80:83], v[100:103], v[48:63]
  ds_read_b128 v[80:83], v4 offset:24576
  v_exp_f32 v16, v16
  v_exp_f32 v17, v17
  v_exp_f32 v18, v18
  v_exp_f32 v19, v19
  v_exp_f32 v20, v20
  v_exp_f32 v21, v21
  v_exp_f32 v22, v22
  v_exp_f32 v23, v23
  v_cvt_pk_bf16_f32 v92, v16, v17
  v_cvt_pk_bf16_f32 v93, v18, v19
  v_cvt_pk_bf16_f32 v94, v20, v21
  v_cvt_pk_bf16_f32 v95, v22, v23
  v_exp_f32 v24, v24
  v_exp_f32 v25, v25
  s_waitcnt lgkmcnt(2)
  v_mfma_f32_32x32x16_bf16 v[64:79], v[84:87], v[92:95], v[64:79]
  ds_read_b128 v[84:87], v6 offset:3072
  v_exp_f32 v26, v26
  v_exp_f32 v27, v27
  v_exp_f32 v28, v28
  v_exp_f32 v29, v29
  v_exp_f32 v30, v30
  v_exp_f32 v31, v31
  v_cvt_pk_bf16_f32 v96, v24, v25
  v_cvt_pk_bf16_f32 v97, v26, v27
  v_cvt_pk_bf16_f32 v98, v28, v29
  v_cvt_pk_bf16_f32 v99, v30, v31
  s_waitcnt lgkmcnt(2)
  s_nop 1
  v_mfma_f32_32x32x16_bf16 v[64:79], v[88:91], v[96:99], v[64:79]
  ds_read_b128 v[88:91], v6 offset:3584
  s_cbranch_scc0 attn_kernel_pr16
  s_setprio 0
attn_kernel_pr16:
  s_waitcnt lgkmcnt(2)
  v_mfma_f32_32x32x16_bf16 v[16:31], v[80:83], v[100:103], v[48:63]
  ds_read_b128 v[80:83], v4 offset:25600
  v_exp_f32 v32, v32
  v_exp_f32 v33, v33
  v_exp_f32 v34, v34
  v_exp_f32 v35, v35
  v_exp_f32 v36, v36
  v_exp_f32 v37, v37
  v_exp_f32 v38, v38
  v_exp_f32 v39, v39
  v_cvt_pk_bf16_f32 v92, v32, v33
  v_cvt_pk_bf16_f32 v93, v34, v35
  v_cvt_pk_bf16_f32 v94, v36, v37
  v_cvt_pk_bf16_f32 v95, v38, v39
  v_exp_f32 v40, v40
  v_exp_f32 v41, v41
  s_waitcnt lgkmcnt(2)
  v_mfma_f32_32x32x16_bf16 v[64:79], v[84:87], v[92:95], v[64:79]
  v_add_u32 v6, v7, v6
  ds_read_b128 v[84:87], v6 offset:0
  v_exp_f32 v42, v42
  v_exp_f32 v43, v43
  v_exp_f32 v44, v44
  v_exp_f32 v45, v45
  v_exp_f32 v46, v46
  v_exp_f32 v47, v47
  v_cvt_pk_bf16_f32 v96, v40, v41
  v_cvt_pk_bf16_f32 v97, v42, v43
  v_cvt_pk_bf16_f32 v98, v44, v45
  v_cvt_pk_bf16_f32 v99, v46, v47
  s_waitcnt lgkmcnt(2)
  s_nop 1
  v_mfma_f32_32x32x16_bf16 v[64:79], v[88:91], v[96:99], v[64:79]
  ds_read_b128 v[88:91], v6 offset:512
  s_cbranch_scc0 attn_kernel_pr17
  s_setprio 2
attn_kernel_pr17:
  s_waitcnt lgkmcnt(2)
  v_mfma_f32_32x32x16_bf16 v[32:47], v[80:83], v[100:103], v[48:63]
  ds_read_b128 v[80:83], v4 offset:26624
  v_exp_f32 v16, v16
  v_exp_f32 v17, v17
  v_exp_f32 v18, v18
  v_exp_f32 v19, v19
  v_exp_f32 v20, v20
  v_exp_f32 v21, v21
  v_exp_f32 v22, v22
  v_exp_f32 v23, v23
  v_cvt_pk_bf16_f32 v92, v16, v17
  v_cvt_pk_bf16_f32 v93, v18, v19
  v_cvt_pk_bf16_f32 v94, v20, v21
  v_cvt_pk_bf16_f32 v95, v22, v23
  v_exp_f32 v24, v24
  v_exp_f32 v25, v25
  s_waitcnt lgkmcnt(2)
  v_mfma_f32_32x32x16_bf16 v[64:79], v[84:87], v[92:95], v[64:79]
  ds_read_b128 v[84:87], v6 offset:1024
  v_exp_f32 v26, v26
  v_exp_f32 v27, v27
  v_exp_f32 v28, v28
  v_exp_f32 v29, v29
  v_exp_f32 v30, v30
  v_exp_f32 v31, v31
  v_cvt_pk_bf16_f32 v96, v24, v25
  v_cvt_pk_bf16_f32 v97, v26, v27
  v_cvt_pk_bf16_f32 v98, v28, v29
  v_cvt_pk_bf16_f32 v99, v30, v31
  s_waitcnt lgkmcnt(2)
  s_nop 1
  v_mfma_f32_32x32x16_bf16 v[64:79], v[88:91], v[96:99], v[64:79]
  ds_read_b128 v[88:91], v6 offset:1536
  s_waitcnt lgkmcnt(2)
  v_mfma_f32_32x32x16_bf16 v[16:31], v[80:83], v[100:103], v[48:63]
  ds_read_b128 v[80:83], v4 offset:27648
  v_exp_f32 v32, v32
  v_exp_f32 v33, v33
  v_exp_f32 v34, v34
  v_exp_f32 v35, v35
  v_exp_f32 v36, v36
  v_exp_f32 v37, v37
  v_exp_f32 v38, v38
  v_exp_f32 v39, v39
  v_cvt_pk_bf16_f32 v92, v32, v33
  v_cvt_pk_bf16_f32 v93, v34, v35
  v_cvt_pk_bf16_f32 v94, v36, v37
  v_cvt_pk_bf16_f32 v95, v38, v39
  v_exp_f32 v40, v40
  v_exp_f32 v41, v41
  s_waitcnt lgkmcnt(2)
  v_mfma_f32_32x32x16_bf16 v[64:79], v[84:87], v[92:95], v[64:79]
  ds_read_b128 v[84:87], v6 offset:2048
  v_exp_f32 v42, v42
  v_exp_f32 v43, v43
  v_exp_f32 v44, v44
  v_exp_f32 v45, v45
  v_exp_f32 v46, v46
  v_exp_f32 v47, v47
  v_cvt_pk_bf16_f32 v96, v40, v41
  v_cvt_pk_bf16_f32 v97, v42, v43
  v_cvt_pk_bf16_f32 v98, v44, v45
  v_cvt_pk_bf16_f32 v99, v46, v47
  s_waitcnt lgkmcnt(2)
  s_nop 1
  v_mfma_f32_32x32x16_bf16 v[64:79], v[88:91], v[96:99], v[64:79]
  ds_read_b128 v[88:91], v6 offset:2560
  s_cbranch_scc0 attn_kernel_pr18
  s_setprio 0
attn_kernel_pr18:
  s_waitcnt lgkmcnt(2)
  v_mfma_f32_32x32x16_bf16 v[32:47], v[80:83], v[100:103], v[48:63]
  ds_read_b128 v[80:83], v4 offset:28672
  v_exp_f32 v16, v16
  v_exp_f32 v17, v17
  v_exp_f32 v18, v18
  v_exp_f32 v19, v19
  v_exp_f32 v20, v20
  v_exp_f32 v21, v21
  v_exp_f32 v22, v22
  v_exp_f32 v23, v23
  v_cvt_pk_bf16_f32 v92, v16, v17
  v_cvt_pk_bf16_f32 v93, v18, v19
  v_cvt_pk_bf16_f32 v94, v20, v21
  v_cvt_pk_bf16_f32 v95, v22, v23
  v_exp_f32 v24, v24
  v_exp_f32 v25, v25
  s_waitcnt lgkmcnt(2)
  v_mfma_f32_32x32x16_bf16 v[64:79], v[84:87], v[92:95], v[64:79]
  ds_read_b128 v[84:87], v6 offset:3072
  v_exp_f32 v26, v26
  v_exp_f32 v27, v27
  v_exp_f32 v28, v28
  v_exp_f32 v29, v29
  v_exp_f32 v30, v30
  v_exp_f32 v31, v31
  v_cvt_pk_bf16_f32 v96, v24, v25
  v_cvt_pk_bf16_f32 v97, v26, v27
  v_cvt_pk_bf16_f32 v98, v28, v29
  v_cvt_pk_bf16_f32 v99, v30, v31
  s_waitcnt lgkmcnt(2)
  s_nop 1
  v_mfma_f32_32x32x16_bf16 v[64:79], v[88:91], v[96:99], v[64:79]
  ds_read_b128 v[88:91], v6 offset:3584
  s_cbranch_scc0 attn_kernel_pr19
  s_setprio 2
attn_kernel_pr19:
  s_waitcnt lgkmcnt(2)
  v_mfma_f32_32x32x16_bf16 v[16:31], v[80:83], v[100:103], v[48:63]
  ds_read_b128 v[80:83], v4 offset:29696
  v_exp_f32 v32, v32
  v_exp_f32 v33, v33
  v_exp_f32 v34, v34
  v_exp_f32 v35, v35
  v_exp_f32 v36, v36
  v_exp_f32 v37, v37
  v_exp_f32 v38, v38
  v_exp_f32 v39, v39
  v_cvt_pk_bf16_f32 v92, v32, v33
  v_cvt_pk_bf16_f32 v93, v34, v35
  v_cvt_pk_bf16_f32 v94, v36, v37
  v_cvt_pk_bf16_f32 v95, v38, v39
  v_exp_f32 v40, v40
  v_exp_f32 v41, v41
  s_waitcnt lgkmcnt(2)
  v_mfma_f32_32x32x16_bf16 v[64:79], v[84:87], v[92:95], v[64:79]
  v_add_u32 v6, v7, v6
  ds_read_b128 v[84:87], v6 offset:0
  v_exp_f32 v42, v42
  v_exp_f32 v43, v43
  v_exp_f32 v44, v44
  v_exp_f32 v45, v45
  v_exp_f32 v46, v46
  v_exp_f32 v47, v47
  v_cvt_pk_bf16_f32 v96, v40, v41
  v_cvt_pk_bf16_f32 v97, v42, v43
  v_cvt_pk_bf16_f32 v98, v44, v45
  v_cvt_pk_bf16_f32 v99, v46, v47
  s_waitcnt lgkmcnt(2)
  s_nop 1
  v_mfma_f32_32x32x16_bf16 v[64:79], v[88:91], v[96:99], v[64:79]
  ds_read_b128 v[88:91], v6 offset:512
  s_waitcnt lgkmcnt(2)
  v_mfma_f32_32x32x16_bf16 v[32:47], v[80:83], v[100:103], v[48:63]
  ds_read_b128 v[80:83], v4 offset:30720
  v_exp_f32 v16, v16
  v_exp_f32 v17, v17
  v_exp_f32 v18, v18
  v_exp_f32 v19, v19
  v_exp_f32 v20, v20
  v_exp_f32 v21, v21
  v_exp_f32 v22, v22
  v_exp_f32 v23, v23
  v_cvt_pk_bf16_f32 v92, v16, v17
  v_cvt_pk_bf16_f32 v93, v18, v19
  v_cvt_pk_bf16_f32 v94, v20, v21
  v_cvt_pk_bf16_f32 v95, v22, v23
  v_exp_f32 v24, v24
  v_exp_f32 v25, v25
  s_waitcnt lgkmcnt(2)
  v_mfma_f32_32x32x16_bf16 v[64:79], v[84:87], v[92:95], v[64:79]
  ds_read_b128 v[84:87], v6 offset:1024
  v_exp_f32 v26, v26
  v_exp_f32 v27, v27
  v_exp_f32 v28, v28
  v_exp_f32 v29, v29
  v_exp_f32 v30, v30
  v_exp_f32 v31, v31
  v_cvt_pk_bf16_f32 v96, v24, v25
  v_cvt_pk_bf16_f32 v97, v26, v27
  v_cvt_pk_bf16_f32 v98, v28, v29
  v_cvt_pk_bf16_f32 v99, v30, v31
  s_waitcnt lgkmcnt(2)
  s_nop 1
  v_mfma_f32_32x32x16_bf16 v[64:79], v[88:91], v[96:99], v[64:79]
  ds_read_b128 v[88:91], v6 offset:1536
  s_cbranch_scc0 attn_kernel_pr20
  s_setprio 0
attn_kernel_pr20:
  s_waitcnt lgkmcnt(2)
  v_mfma_f32_32x32x16_bf16 v[16:31], v[80:83], v[100:103], v[48:63]
  ds_read_b128 v[80:83], v4 offset:31744
  v_exp_f32 v32, v32
  v_exp_f32 v33, v33
  v_exp_f32 v34, v34
  v_exp_f32 v35, v35
  v_exp_f32 v36, v36
  v_exp_f32 v37, v37
  v_exp_f32 v38, v38
  v_exp_f32 v39, v39
  v_cvt_pk_bf16_f32 v92, v32, v33
  v_cvt_pk_bf16_f32 v93, v34, v35
  v_cvt_pk_bf16_f32 v94, v36, v37
  v_cvt_pk_bf16_f32 v95, v38, v39
  v_exp_f32 v40, v40
  v_exp_f32 v41, v41
  s_waitcnt lgkmcnt(2)
  v_mfma_f32_32x32x16_bf16 v[64:79], v[84:87], v[92:95], v[64:79]
  ds_read_b128 v[84:87], v6 offset:2048
  v_exp_f32 v42, v42
  v_exp_f32 v43, v43
  v_exp_f32 v44, v44
  v_exp_f32 v45, v45
  v_exp_f32 v46, v46
  v_exp_f32 v47, v47
  v_cvt_pk_bf16_f32 v96, v40, v41
  v_cvt_pk_bf16_f32 v97, v42, v43
  v_cvt_pk_bf16_f32 v98, v44, v45
  v_cvt_pk_bf16_f32 v99, v46, v47
  s_waitcnt lgkmcnt(2)
  s_nop 1
  v_mfma_f32_32x32x16_bf16 v[64:79], v[88:91], v[96:99], v[64:79]
  ds_read_b128 v[88:91], v6 offset:2560
  s_cbranch_scc0 attn_kernel_pr21
  s_setprio 2
attn_kernel_pr21:
  s_waitcnt lgkmcnt(2)
  v_mfma_f32_32x32x16_bf16 v[32:47], v[80:83], v[100:103], v[48:63]
  ds_read_b128 v[80:83], v4 offset:32768
  v_exp_f32 v16, v16
  v_exp_f32 v17, v17
  v_exp_f32 v18, v18
  v_exp_f32 v19, v19
  v_exp_f32 v20, v20
  v_exp_f32 v21, v21
  v_exp_f32 v22, v22
  v_exp_f32 v23, v23
  v_cvt_pk_bf16_f32 v92, v16, v17
  v_cvt_pk_bf16_f32 v93, v18, v19
  v_cvt_pk_bf16_f32 v94, v20, v21
  v_cvt_pk_bf16_f32 v95, v22, v23
  v_exp_f32 v24, v24
  v_exp_f32 v25, v25
  s_waitcnt lgkmcnt(2)
  v_mfma_f32_32x32x16_bf16 v[64:79], v[84:87], v[92:95], v[64:79]
  ds_read_b128 v[84:87], v6 offset:3072
  v_exp_f32 v26, v26
  v_exp_f32 v27, v27
  v_exp_f32 v28, v28
  v_exp_f32 v29, v29
  v_exp_f32 v30, v30
  v_exp_f32 v31, v31
  v_cvt_pk_bf16_f32 v96, v24, v25
  v_cvt_pk_bf16_f32 v97, v26, v27
  v_cvt_pk_bf16_f32 v98, v28, v29
  v_cvt_pk_bf16_f32 v99, v30, v31
  s_waitcnt lgkmcnt(2)
  s_nop 1
  v_mfma_f32_32x32x16_bf16 v[64:79], v[88:91], v[96:99], v[64:79]
  ds_read_b128 v[88:91], v6 offset:3584
  s_waitcnt lgkmcnt(2)
  v_mfma_f32_32x32x16_bf16 v[16:31], v[80:83], v[100:103], v[48:63]
  ds_read_b128 v[80:83], v4 offset:33792
  v_exp_f32 v32, v32
  v_exp_f32 v33, v33
  v_exp_f32 v34, v34
  v_exp_f32 v35, v35
  v_exp_f32 v36, v36
  v_exp_f32 v37, v37
  v_exp_f32 v38, v38
  v_exp_f32 v39, v39
  v_cvt_pk_bf16_f32 v92, v32, v33
  v_cvt_pk_bf16_f32 v93, v34, v35
  v_cvt_pk_bf16_f32 v94, v36, v37
  v_cvt_pk_bf16_f32 v95, v38, v39
  v_exp_f32 v40, v40
  v_exp_f32 v41, v41
  s_waitcnt lgkmcnt(2)
  v_mfma_f32_32x32x16_bf16 v[64:79], v[84:87], v[92:95], v[64:79]
  v_add_u32 v6, v7, v6
  ds_read_b128 v[84:87], v6 offset:0
  v_exp_f32 v42, v42
  v_exp_f32 v43, v43
  v_exp_f32 v44, v44
  v_exp_f32 v45, v45
  v_exp_f32 v46, v46
  v_exp_f32 v47, v47
  v_cvt_pk_bf16_f32 v96, v40, v41
  v_cvt_pk_bf16_f32 v97, v42, v43
  v_cvt_pk_bf16_f32 v98, v44, v45
  v_cvt_pk_bf16_f32 v99, v46, v47
  s_waitcnt lgkmcnt(2)
  s_nop 1
  v_mfma_f32_32x32x16_bf16 v[64:79], v[88:91], v[96:99], v[64:79]
  ds_read_b128 v[88:91], v6 offset:512
  s_cbranch_scc0 attn_kernel_pr22
  s_setprio 0
attn_kernel_pr22:
  s_waitcnt lgkmcnt(2)
  v_mfma_f32_32x32x16_bf16 v[32:47], v[80:83], v[100:103], v[48:63]
  ds_read_b128 v[80:83], v4 offset:34816
  v_exp_f32 v16, v16
  v_exp_f32 v17, v17
  v_exp_f32 v18, v18
  v_exp_f32 v19, v19
  v_exp_f32 v20, v20
  v_exp_f32 v21, v21
  v_exp_f32 v22, v22
  v_exp_f32 v23, v23
  v_cvt_pk_bf16_f32 v92, v16, v17
  v_cvt_pk_bf16_f32 v93, v18, v19
  v_cvt_pk_bf16_f32 v94, v20, v21
  v_cvt_pk_bf16_f32 v95, v22, v23
  v_exp_f32 v24, v24
  v_exp_f32 v25, v25
  s_waitcnt lgkmcnt(2)
  v_mfma_f32_32x32x16_bf16 v[64:79], v[84:87], v[92:95], v[64:79]
  ds_read_b128 v[84:87], v6 offset:1024
  v_exp_f32 v26, v26
  v_exp_f32 v27, v27
  v_exp_f32 v28, v28
  v_exp_f32 v29, v29
  v_exp_f32 v30, v30
  v_exp_f32 v31, v31
  v_cvt_pk_bf16_f32 v96, v24, v25
  v_cvt_pk_bf16_f32 v97, v26, v27
  v_cvt_pk_bf16_f32 v98, v28, v29
  v_cvt_pk_bf16_f32 v99, v30, v31
  s_waitcnt lgkmcnt(2)
  s_nop 1
  v_mfma_f32_32x32x16_bf16 v[64:79], v[88:91], v[96:99], v[64:79]
  ds_read_b128 v[88:91], v6 offset:1536
  s_cbranch_scc0 attn_kernel_pr23
  s_setprio 2
attn_kernel_pr23:
  s_waitcnt lgkmcnt(2)
  v_mfma_f32_32x32x16_bf16 v[16:31], v[80:83], v[100:103], v[48:63]
  ds_read_b128 v[80:83], v4 offset:35840
  v_exp_f32 v32, v32
  v_exp_f32 v33, v33
  v_exp_f32 v34, v34
  v_exp_f32 v35, v35
  v_exp_f32 v36, v36
  v_exp_f32 v37, v37
  v_exp_f32 v38, v38
  v_exp_f32 v39, v39
  v_cvt_pk_bf16_f32 v92, v32, v33
  v_cvt_pk_bf16_f32 v93, v34, v35
  v_cvt_pk_bf16_f32 v94, v36, v37
  v_cvt_pk_bf16_f32 v95, v38, v39
  v_exp_f32 v40, v40
  v_exp_f32 v41, v41
  s_waitcnt lgkmcnt(2)
  v_mfma_f32_32x32x16_bf16 v[64:79], v[84:87], v[92:95], v[64:79]
  ds_read_b128 v[84:87], v6 offset:2048
  v_exp_f32 v42, v42
  v_exp_f32 v43, v43
  v_exp_f32 v44, v44
  v_exp_f32 v45, v45
  v_exp_f32 v46, v46
  v_exp_f32 v47, v47
  v_cvt_pk_bf16_f32 v96, v40, v41
  v_cvt_pk_bf16_f32 v97, v42, v43
  v_cvt_pk_bf16_f32 v98, v44, v45
  v_cvt_pk_bf16_f32 v99, v46, v47
  s_waitcnt lgkmcnt(2)
  s_nop 1
  v_mfma_f32_32x32x16_bf16 v[64:79], v[88:91], v[96:99], v[64:79]
  ds_read_b128 v[88:91], v6 offset:2560
  s_waitcnt lgkmcnt(2)
  v_mfma_f32_32x32x16_bf16 v[32:47], v[80:83], v[100:103], v[48:63]
  ds_read_b128 v[80:83], v4 offset:36864
  v_exp_f32 v16, v16
  v_exp_f32 v17, v17
  v_exp_f32 v18, v18
  v_exp_f32 v19, v19
  v_exp_f32 v20, v20
  v_exp_f32 v21, v21
  v_exp_f32 v22, v22
  v_exp_f32 v23, v23
  v_cvt_pk_bf16_f32 v92, v16, v17
  v_cvt_pk_bf16_f32 v93, v18, v19
  v_cvt_pk_bf16_f32 v94, v20, v21
  v_cvt_pk_bf16_f32 v95, v22, v23
  v_exp_f32 v24, v24
  v_exp_f32 v25, v25
  s_waitcnt lgkmcnt(2)
  v_mfma_f32_32x32x16_bf16 v[64:79], v[84:87], v[92:95], v[64:79]
  ds_read_b128 v[84:87], v6 offset:3072
  v_exp_f32 v26, v26
  v_exp_f32 v27, v27
  v_exp_f32 v28, v28
  v_exp_f32 v29, v29
  v_exp_f32 v30, v30
  v_exp_f32 v31, v31
  v_cvt_pk_bf16_f32 v96, v24, v25
  v_cvt_pk_bf16_f32 v97, v26, v27
  v_cvt_pk_bf16_f32 v98, v28, v29
  v_cvt_pk_bf16_f32 v99, v30, v31
  s_waitcnt lgkmcnt(2)
  s_nop 1
  v_mfma_f32_32x32x16_bf16 v[64:79], v[88:91], v[96:99], v[64:79]
  ds_read_b128 v[88:91], v6 offset:3584
  s_cbranch_scc0 attn_kernel_pr24
  s_setprio 0
attn_kernel_pr24:
  s_waitcnt lgkmcnt(2)
  v_mfma_f32_32x32x16_bf16 v[16:31], v[80:83], v[100:103], v[48:63]
  ds_read_b128 v[80:83], v4 offset:37888
  v_exp_f32 v32, v32
  v_exp_f32 v33, v33
  v_exp_f32 v34, v34
  v_exp_f32 v35, v35
  v_exp_f32 v36, v36
  v_exp_f32 v37, v37
  v_exp_f32 v38, v38
  v_exp_f32 v39, v39
  v_cvt_pk_bf16_f32 v92, v32, v33
  v_cvt_pk_bf16_f32 v93, v34, v35
  v_cvt_pk_bf16_f32 v94, v36, v37
  v_cvt_pk_bf16_f32 v95, v38, v39
  v_exp_f32 v40, v40
  v_exp_f32 v41, v41
  s_waitcnt lgkmcnt(2)
  v_mfma_f32_32x32x16_bf16 v[64:79], v[84:87], v[92:95], v[64:79]
  v_add_u32 v6, v7, v6
  ds_read_b128 v[84:87], v6 offset:0
  v_exp_f32 v42, v42
  v_exp_f32 v43, v43
  v_exp_f32 v44, v44
  v_exp_f32 v45, v45
  v_exp_f32 v46, v46
  v_exp_f32 v47, v47
  v_cvt_pk_bf16_f32 v96, v40, v41
  v_cvt_pk_bf16_f32 v97, v42, v43
  v_cvt_pk_bf16_f32 v98, v44, v45
  v_cvt_pk_bf16_f32 v99, v46, v47
  s_waitcnt lgkmcnt(2)
  s_nop 1
  v_mfma_f32_32x32x16_bf16 v[64:79], v[88:91], v[96:99], v[64:79]
  ds_read_b128 v[88:91], v6 offset:512
  s_cbranch_scc0 attn_kernel_pr25
  s_setprio 2
attn_kernel_pr25:
  s_waitcnt lgkmcnt(2)
  v_mfma_f32_32x32x16_bf16 v[32:47], v[80:83], v[100:103], v[48:63]
  ds_read_b128 v[80:83], v4 offset:38912
  v_exp_f32 v16, v16
  v_exp_f32 v17, v17
  v_exp_f32 v18, v18
  v_exp_f32 v19, v19
  v_exp_f32 v20, v20
  v_exp_f32 v21, v21
  v_exp_f32 v22, v22
  v_exp_f32 v23, v23
  v_cvt_pk_bf16_f32 v92, v16, v17
  v_cvt_pk_bf16_f32 v93, v18, v19
  v_cvt_pk_bf16_f32 v94, v20, v21
  v_cvt_pk_bf16_f32 v95, v22, v23
  v_exp_f32 v24, v24
  v_exp_f32 v25, v25
  s_waitcnt lgkmcnt(2)
  v_mfma_f32_32x32x16_bf16 v[64:79], v[84:87], v[92:95], v[64:79]
  ds_read_b128 v[84:87], v6 offset:1024
  v_exp_f32 v26, v26
  v_exp_f32 v27, v27
  v_exp_f32 v28, v28
  v_exp_f32 v29, v29
  v_exp_f32 v30, v30
  v_exp_f32 v31, v31
  v_cvt_pk_bf16_f32 v96, v24, v25
  v_cvt_pk_bf16_f32 v97, v26, v27
  v_cvt_pk_bf16_f32 v98, v28, v29
  v_cvt_pk_bf16_f32 v99, v30, v31
  s_waitcnt lgkmcnt(2)
  s_nop 1
  v_mfma_f32_32x32x16_bf16 v[64:79], v[88:91], v[96:99], v[64:79]
  ds_read_b128 v[88:91], v6 offset:1536
  s_waitcnt lgkmcnt(2)
  v_mfma_f32_32x32x16_bf16 v[16:31], v[80:83], v[100:103], v[48:63]
  ds_read_b128 v[80:83], v4 offset:39936
  v_exp_f32 v32, v32
  v_exp_f32 v33, v33
  v_exp_f32 v34, v34
  v_exp_f32 v35, v35
  v_exp_f32 v36, v36
  v_exp_f32 v37, v37
  v_exp_f32 v38, v38
  v_exp_f32 v39, v39
  v_cvt_pk_bf16_f32 v92, v32, v33
  v_cvt_pk_bf16_f32 v93, v34, v35
  v_cvt_pk_bf16_f32 v94, v36, v37
  v_cvt_pk_bf16_f32 v95, v38, v39
  v_exp_f32 v40, v40
  v_exp_f32 v41, v41
  s_waitcnt lgkmcnt(2)
  v_mfma_f32_32x32x16_bf16 v[64:79], v[84:87], v[92:95], v[64:79]
  ds_read_b128 v[84:87], v6 offset:2048
  v_exp_f32 v42, v42
  v_exp_f32 v43, v43
  v_exp_f32 v44, v44
  v_exp_f32 v45, v45
  v_exp_f32 v46, v46
  v_exp_f32 v47, v47
  v_cvt_pk_bf16_f32 v96, v40, v41
  v_cvt_pk_bf16_f32 v97, v42, v43
  v_cvt_pk_bf16_f32 v98, v44, v45
  v_cvt_pk_bf16_f32 v99, v46, v47
  s_waitcnt lgkmcnt(2)
  s_nop 1
  v_mfma_f32_32x32x16_bf16 v[64:79], v[88:91], v[96:99], v[64:79]
  ds_read_b128 v[88:91], v6 offset:2560
  s_cbranch_scc0 attn_kernel_pr26
  s_setprio 0
attn_kernel_pr26:
  s_waitcnt lgkmcnt(2)
  v_mfma_f32_32x32x16_bf16 v[32:47], v[80:83], v[100:103], v[48:63]
  ds_read_b128 v[80:83], v4 offset:40960
  v_exp_f32 v16, v16
  v_exp_f32 v17, v17
  v_exp_f32 v18, v18
  v_exp_f32 v19, v19
  v_exp_f32 v20, v20
  v_exp_f32 v21, v21
  v_exp_f32 v22, v22
  v_exp_f32 v23, v23
  v_cvt_pk_bf16_f32 v92, v16, v17
  v_cvt_pk_bf16_f32 v93, v18, v19
  v_cvt_pk_bf16_f32 v94, v20, v21
  v_cvt_pk_bf16_f32 v95, v22, v23
  v_exp_f32 v24, v24
  v_exp_f32 v25, v25
  s_waitcnt lgkmcnt(2)
  v_mfma_f32_32x32x16_bf16 v[64:79], v[84:87], v[92:95], v[64:79]
  ds_read_b128 v[84:87], v6 offset:3072
  v_exp_f32 v26, v26
  v_exp_f32 v27, v27
  v_exp_f32 v28, v28
  v_exp_f32 v29, v29
  v_exp_f32 v30, v30
  v_exp_f32 v31, v31
  v_cvt_pk_bf16_f32 v96, v24, v25
  v_cvt_pk_bf16_f32 v97, v26, v27
  v_cvt_pk_bf16_f32 v98, v28, v29
  v_cvt_pk_bf16_f32 v99, v30, v31
  s_waitcnt lgkmcnt(2)
  s_nop 1
  v_mfma_f32_32x32x16_bf16 v[64:79], v[88:91], v[96:99], v[64:79]
  ds_read_b128 v[88:91], v6 offset:3584
  s_cbranch_scc0 attn_kernel_pr27
  s_setprio 2
attn_kernel_pr27:
  s_waitcnt lgkmcnt(2)
  v_mfma_f32_32x32x16_bf16 v[16:31], v[80:83], v[100:103], v[48:63]
  ds_read_b128 v[80:83], v4 offset:41984
  v_exp_f32 v32, v32
  v_exp_f32 v33, v33
  v_exp_f32 v34, v34
  v_exp_f32 v35, v35
  v_exp_f32 v36, v36
  v_exp_f32 v37, v37
  v_exp_f32 v38, v38
  v_exp_f32 v39, v39
  v_cvt_pk_bf16_f32 v92, v32, v33
  v_cvt_pk_bf16_f32 v93, v34, v35
  v_cvt_pk_bf16_f32 v94, v36, v37
  v_cvt_pk_bf16_f32 v95, v38, v39
  v_exp_f32 v40, v40
  v_exp_f32 v41, v41
  s_waitcnt lgkmcnt(2)
  v_mfma_f32_32x32x16_bf16 v[64:79], v[84:87], v[92:95], v[64:79]
  v_add_u32 v6, v7, v6
  ds_read_b128 v[84:87], v6 offset:0
  v_exp_f32 v42, v42
  v_exp_f32 v43, v43
  v_exp_f32 v44, v44
  v_exp_f32 v45, v45
  v_exp_f32 v46, v46
  v_exp_f32 v47, v47
  v_cvt_pk_bf16_f32 v96, v40, v41
  v_cvt_pk_bf16_f32 v97, v42, v43
  v_cvt_pk_bf16_f32 v98, v44, v45
  v_cvt_pk_bf16_f32 v99, v46, v47
  s_waitcnt lgkmcnt(2)
  s_nop 1
  v_mfma_f32_32x32x16_bf16 v[64:79], v[88:91], v[96:99], v[64:79]
  ds_read_b128 v[88:91], v6 offset:512
  s_waitcnt lgkmcnt(2)
  v_mfma_f32_32x32x16_bf16 v[32:47], v[80:83], v[100:103], v[48:63]
  ds_read_b128 v[80:83], v4 offset:43008
  v_exp_f32 v16, v16
  v_exp_f32 v17, v17
  v_exp_f32 v18, v18
  v_exp_f32 v19, v19
  v_exp_f32 v20, v20
  v_exp_f32 v21, v21
  v_exp_f32 v22, v22
  v_exp_f32 v23, v23
  v_cvt_pk_bf16_f32 v92, v16, v17
  v_cvt_pk_bf16_f32 v93, v18, v19
  v_cvt_pk_bf16_f32 v94, v20, v21
  v_cvt_pk_bf16_f32 v95, v22, v23
  v_exp_f32 v24, v24
  v_exp_f32 v25, v25
  s_waitcnt lgkmcnt(2)
  v_mfma_f32_32x32x16_bf16 v[64:79], v[84:87], v[92:95], v[64:79]
  ds_read_b128 v[84:87], v6 offset:1024
  v_exp_f32 v26, v26
  v_exp_f32 v27, v27
  v_exp_f32 v28, v28
  v_exp_f32 v29, v29
  v_exp_f32 v30, v30
  v_exp_f32 v31, v31
  v_cvt_pk_bf16_f32 v96, v24, v25
  v_cvt_pk_bf16_f32 v97, v26, v27
  v_cvt_pk_bf16_f32 v98, v28, v29
  v_cvt_pk_bf16_f32 v99, v30, v31
  s_waitcnt lgkmcnt(2)
  s_nop 1
  v_mfma_f32_32x32x16_bf16 v[64:79], v[88:91], v[96:99], v[64:79]
  ds_read_b128 v[88:91], v6 offset:1536
  s_cbranch_scc0 attn_kernel_pr28
  s_setprio 0
attn_kernel_pr28:
  s_waitcnt lgkmcnt(2)
  v_mfma_f32_32x32x16_bf16 v[16:31], v[80:83], v[100:103], v[48:63]
  ds_read_b128 v[80:83], v4 offset:44032
  v_exp_f32 v32, v32
  v_exp_f32 v33, v33
  v_exp_f32 v34, v34
  v_exp_f32 v35, v35
  v_exp_f32 v36, v36
  v_exp_f32 v37, v37
  v_exp_f32 v38, v38
  v_exp_f32 v39, v39
  v_cvt_pk_bf16_f32 v92, v32, v33
  v_cvt_pk_bf16_f32 v93, v34, v35
  v_cvt_pk_bf16_f32 v94, v36, v37
  v_cvt_pk_bf16_f32 v95, v38, v39
  v_exp_f32 v40, v40
  v_exp_f32 v41, v41
  s_waitcnt lgkmcnt(2)
  v_mfma_f32_32x32x16_bf16 v[64:79], v[84:87], v[92:95], v[64:79]
  ds_read_b128 v[84:87], v6 offset:2048
  v_exp_f32 v42, v42
  v_exp_f32 v43, v43
  v_exp_f32 v44, v44
  v_exp_f32 v45, v45
  v_exp_f32 v46, v46
  v_exp_f32 v47, v47
  v_cvt_pk_bf16_f32 v96, v40, v41
  v_cvt_pk_bf16_f32 v97, v42, v43
  v_cvt_pk_bf16_f32 v98, v44, v45
  v_cvt_pk_bf16_f32 v99, v46, v47
  s_waitcnt lgkmcnt(2)
  s_nop 1
  v_mfma_f32_32x32x16_bf16 v[64:79], v[88:91], v[96:99], v[64:79]
  ds_read_b128 v[88:91], v6 offset:2560
  s_cbranch_scc0 attn_kernel_pr29
  s_setprio 2
attn_kernel_pr29:
  s_waitcnt lgkmcnt(2)
  v_mfma_f32_32x32x16_bf16 v[32:47], v[80:83], v[100:103], v[48:63]
  ds_read_b128 v[80:83], v4 offset:45056
  v_exp_f32 v16, v16
  v_exp_f32 v17, v17
  v_exp_f32 v18, v18
  v_exp_f32 v19, v19
  v_exp_f32 v20, v20
  v_exp_f32 v21, v21
  v_exp_f32 v22, v22
  v_exp_f32 v23, v23
  v_cvt_pk_bf16_f32 v92, v16, v17
  v_cvt_pk_bf16_f32 v93, v18, v19
  v_cvt_pk_bf16_f32 v94, v20, v21
  v_cvt_pk_bf16_f32 v95, v22, v23
  v_exp_f32 v24, v24
  v_exp_f32 v25, v25
  s_waitcnt lgkmcnt(2)
  v_mfma_f32_32x32x16_bf16 v[64:79], v[84:87], v[92:95], v[64:79]
  ds_read_b128 v[84:87], v6 offset:3072
  v_exp_f32 v26, v26
  v_exp_f32 v27, v27
  v_exp_f32 v28, v28
  v_exp_f32 v29, v29
  v_exp_f32 v30, v30
  v_exp_f32 v31, v31
  v_cvt_pk_bf16_f32 v96, v24, v25
  v_cvt_pk_bf16_f32 v97, v26, v27
  v_cvt_pk_bf16_f32 v98, v28, v29
  v_cvt_pk_bf16_f32 v99, v30, v31
  s_waitcnt lgkmcnt(2)
  s_nop 1
  v_mfma_f32_32x32x16_bf16 v[64:79], v[88:91], v[96:99], v[64:79]
  ds_read_b128 v[88:91], v6 offset:3584
  s_waitcnt lgkmcnt(2)
  v_mfma_f32_32x32x16_bf16 v[16:31], v[80:83], v[100:103], v[48:63]
  ds_read_b128 v[80:83], v4 offset:46080
  v_exp_f32 v32, v32
  v_exp_f32 v33, v33
  v_exp_f32 v34, v34
  v_exp_f32 v35, v35
  v_exp_f32 v36, v36
  v_exp_f32 v37, v37
  v_exp_f32 v38, v38
  v_exp_f32 v39, v39
  v_cvt_pk_bf16_f32 v92, v32, v33
  v_cvt_pk_bf16_f32 v93, v34, v35
  v_cvt_pk_bf16_f32 v94, v36, v37
  v_cvt_pk_bf16_f32 v95, v38, v39
  v_exp_f32 v40, v40
  v_exp_f32 v41, v41
  s_waitcnt lgkmcnt(2)
  v_mfma_f32_32x32x16_bf16 v[64:79], v[84:87], v[92:95], v[64:79]
  v_add_u32 v6, v7, v6
  ds_read_b128 v[84:87], v6 offset:0
  v_exp_f32 v42, v42
  v_exp_f32 v43, v43
  v_exp_f32 v44, v44
  v_exp_f32 v45, v45
  v_exp_f32 v46, v46
  v_exp_f32 v47, v47
  v_cvt_pk_bf16_f32 v96, v40, v41
  v_cvt_pk_bf16_f32 v97, v42, v43
  v_cvt_pk_bf16_f32 v98, v44, v45
  v_cvt_pk_bf16_f32 v99, v46, v47
  s_waitcnt lgkmcnt(2)
  s_nop 1
  v_mfma_f32_32x32x16_bf16 v[64:79], v[88:91], v[96:99], v[64:79]
  ds_read_b128 v[88:91], v6 offset:512
  s_cbranch_scc0 attn_kernel_pr30
  s_setprio 0
attn_kernel_pr30:
  s_waitcnt lgkmcnt(2)
  v_mfma_f32_32x32x16_bf16 v[32:47], v[80:83], v[100:103], v[48:63]
  ds_read_b128 v[80:83], v4 offset:47104
  v_exp_f32 v16, v16
  v_exp_f32 v17, v17
  v_exp_f32 v18, v18
  v_exp_f32 v19, v19
  v_exp_f32 v20, v20
  v_exp_f32 v21, v21
  v_exp_f32 v22, v22
  v_exp_f32 v23, v23
  v_cvt_pk_bf16_f32 v92, v16, v17
  v_cvt_pk_bf16_f32 v93, v18, v19
  v_cvt_pk_bf16_f32 v94, v20, v21
  v_cvt_pk_bf16_f32 v95, v22, v23
  v_exp_f32 v24, v24
  v_exp_f32 v25, v25
  s_waitcnt lgkmcnt(2)
  v_mfma_f32_32x32x16_bf16 v[64:79], v[84:87], v[92:95], v[64:79]
  ds_read_b128 v[84:87], v6 offset:1024
  v_exp_f32 v26, v26
  v_exp_f32 v27, v27
  v_exp_f32 v28, v28
  v_exp_f32 v29, v29
  v_exp_f32 v30, v30
  v_exp_f32 v31, v31
  v_cvt_pk_bf16_f32 v96, v24, v25
  v_cvt_pk_bf16_f32 v97, v26, v27
  v_cvt_pk_bf16_f32 v98, v28, v29
  v_cvt_pk_bf16_f32 v99, v30, v31
  s_waitcnt lgkmcnt(2)
  s_nop 1
  v_mfma_f32_32x32x16_bf16 v[64:79], v[88:91], v[96:99], v[64:79]
  ds_read_b128 v[88:91], v6 offset:1536
  s_cbranch_scc0 attn_kernel_pr31
  s_setprio 2
attn_kernel_pr31:
  s_waitcnt lgkmcnt(2)
  v_mfma_f32_32x32x16_bf16 v[16:31], v[80:83], v[100:103], v[48:63]
  ds_read_b128 v[80:83], v4 offset:48128
  v_exp_f32 v32, v32
  v_exp_f32 v33, v33
  v_exp_f32 v34, v34
  v_exp_f32 v35, v35
  v_exp_f32 v36, v36
  v_exp_f32 v37, v37
  v_exp_f32 v38, v38
  v_exp_f32 v39, v39
  v_cvt_pk_bf16_f32 v92, v32, v33
  v_cvt_pk_bf16_f32 v93, v34, v35
  v_cvt_pk_bf16_f32 v94, v36, v37
  v_cvt_pk_bf16_f32 v95, v38, v39
  v_exp_f32 v40, v40
  v_exp_f32 v41, v41
  s_waitcnt lgkmcnt(2)
  v_mfma_f32_32x32x16_bf16 v[64:79], v[84:87], v[92:95], v[64:79]
  ds_read_b128 v[84:87], v6 offset:2048
  v_exp_f32 v42, v42
  v_exp_f32 v43, v43
  v_exp_f32 v44, v44
  v_exp_f32 v45, v45
  v_exp_f32 v46, v46
  v_exp_f32 v47, v47
  v_cvt_pk_bf16_f32 v96, v40, v41
  v_cvt_pk_bf16_f32 v97, v42, v43
  v_cvt_pk_bf16_f32 v98, v44, v45
  v_cvt_pk_bf16_f32 v99, v46, v47
  s_waitcnt lgkmcnt(2)
  s_nop 1
  v_mfma_f32_32x32x16_bf16 v[64:79], v[88:91], v[96:99], v[64:79]
  ds_read_b128 v[88:91], v6 offset:2560
  s_waitcnt lgkmcnt(2)
  v_mfma_f32_32x32x16_bf16 v[32:47], v[80:83], v[100:103], v[48:63]
  ds_read_b128 v[80:83], v4 offset:49152
  v_exp_f32 v16, v16
  v_exp_f32 v17, v17
  v_exp_f32 v18, v18
  v_exp_f32 v19, v19
  v_exp_f32 v20, v20
  v_exp_f32 v21, v21
  v_exp_f32 v22, v22
  v_exp_f32 v23, v23
  v_cvt_pk_bf16_f32 v92, v16, v17
  v_cvt_pk_bf16_f32 v93, v18, v19
  v_cvt_pk_bf16_f32 v94, v20, v21
  v_cvt_pk_bf16_f32 v95, v22, v23
  v_exp_f32 v24, v24
  v_exp_f32 v25, v25
  s_waitcnt lgkmcnt(2)
  v_mfma_f32_32x32x16_bf16 v[64:79], v[84:87], v[92:95], v[64:79]
  ds_read_b128 v[84:87], v6 offset:3072
  v_exp_f32 v26, v26
  v_exp_f32 v27, v27
  v_exp_f32 v28, v28
  v_exp_f32 v29, v29
  v_exp_f32 v30, v30
  v_exp_f32 v31, v31
  v_cvt_pk_bf16_f32 v96, v24, v25
  v_cvt_pk_bf16_f32 v97, v26, v27
  v_cvt_pk_bf16_f32 v98, v28, v29
  v_cvt_pk_bf16_f32 v99, v30, v31
  s_waitcnt lgkmcnt(2)
  s_nop 1
  v_mfma_f32_32x32x16_bf16 v[64:79], v[88:91], v[96:99], v[64:79]
  ds_read_b128 v[88:91], v6 offset:3584
  s_cbranch_scc0 attn_kernel_pr32
  s_setprio 0
attn_kernel_pr32:
  s_waitcnt lgkmcnt(2)
  v_mfma_f32_32x32x16_bf16 v[16:31], v[80:83], v[100:103], v[48:63]
  ds_read_b128 v[80:83], v4 offset:50176
  v_exp_f32 v32, v32
  v_exp_f32 v33, v33
  v_exp_f32 v34, v34
  v_exp_f32 v35, v35
  v_exp_f32 v36, v36
  v_exp_f32 v37, v37
  v_exp_f32 v38, v38
  v_exp_f32 v39, v39
  v_cvt_pk_bf16_f32 v92, v32, v33
  v_cvt_pk_bf16_f32 v93, v34, v35
  v_cvt_pk_bf16_f32 v94, v36, v37
  v_cvt_pk_bf16_f32 v95, v38, v39
  v_exp_f32 v40, v40
  v_exp_f32 v41, v41
  s_waitcnt lgkmcnt(2)
  v_mfma_f32_32x32x16_bf16 v[64:79], v[84:87], v[92:95], v[64:79]
  v_add_u32 v6, v7, v6
  ds_read_b128 v[84:87], v6 offset:0
  v_exp_f32 v42, v42
  v_exp_f32 v43, v43
  v_exp_f32 v44, v44
  v_exp_f32 v45, v45
  v_exp_f32 v46, v46
  v_exp_f32 v47, v47
  v_cvt_pk_bf16_f32 v96, v40, v41
  v_cvt_pk_bf16_f32 v97, v42, v43
  v_cvt_pk_bf16_f32 v98, v44, v45
  v_cvt_pk_bf16_f32 v99, v46, v47
  s_waitcnt lgkmcnt(2)
  s_nop 1
  v_mfma_f32_32x32x16_bf16 v[64:79], v[88:91], v[96:99], v[64:79]
  ds_read_b128 v[88:91], v6 offset:512
  s_cbranch_scc0 attn_kernel_pr33
  s_setprio 2
attn_kernel_pr33:
  s_waitcnt lgkmcnt(2)
  v_mfma_f32_32x32x16_bf16 v[32:47], v[80:83], v[100:103], v[48:63]
  ds_read_b128 v[80:83], v4 offset:51200
  v_exp_f32 v16, v16
  v_exp_f32 v17, v17
  v_exp_f32 v18, v18
  v_exp_f32 v19, v19
  v_exp_f32 v20, v20
  v_exp_f32 v21, v21
  v_exp_f32 v22, v22
  v_exp_f32 v23, v23
  v_cvt_pk_bf16_f32 v92, v16, v17
  v_cvt_pk_bf16_f32 v93, v18, v19
  v_cvt_pk_bf16_f32 v94, v20, v21
  v_cvt_pk_bf16_f32 v95, v22, v23
  v_exp_f32 v24, v24
  v_exp_f32 v25, v25
  s_waitcnt lgkmcnt(2)
  v_mfma_f32_32x32x16_bf16 v[64:79], v[84:87], v[92:95], v[64:79]
  ds_read_b128 v[84:87], v6 offset:1024
  v_exp_f32 v26, v26
  v_exp_f32 v27, v27
  v_exp_f32 v28, v28
  v_exp_f32 v29, v29
  v_exp_f32 v30, v30
  v_exp_f32 v31, v31
  v_cvt_pk_bf16_f32 v96, v24, v25
  v_cvt_pk_bf16_f32 v97, v26, v27
  v_cvt_pk_bf16_f32 v98, v28, v29
  v_cvt_pk_bf16_f32 v99, v30, v31
  s_waitcnt lgkmcnt(2)
  s_nop 1
  v_mfma_f32_32x32x16_bf16 v[64:79], v[88:91], v[96:99], v[64:79]
  ds_read_b128 v[88:91], v6 offset:1536
  s_waitcnt lgkmcnt(2)
  v_mfma_f32_32x32x16_bf16 v[16:31], v[80:83], v[100:103], v[48:63]
  ds_read_b128 v[80:83], v4 offset:52224
  v_exp_f32 v32, v32
  v_exp_f32 v33, v33
  v_exp_f32 v34, v34
  v_exp_f32 v35, v35
  v_exp_f32 v36, v36
  v_exp_f32 v37, v37
  v_exp_f32 v38, v38
  v_exp_f32 v39, v39
  v_cvt_pk_bf16_f32 v92, v32, v33
  v_cvt_pk_bf16_f32 v93, v34, v35
  v_cvt_pk_bf16_f32 v94, v36, v37
  v_cvt_pk_bf16_f32 v95, v38, v39
  v_exp_f32 v40, v40
  v_exp_f32 v41, v41
  s_waitcnt lgkmcnt(2)
  v_mfma_f32_32x32x16_bf16 v[64:79], v[84:87], v[92:95], v[64:79]
  ds_read_b128 v[84:87], v6 offset:2048
  v_exp_f32 v42, v42
  v_exp_f32 v43, v43
  v_exp_f32 v44, v44
  v_exp_f32 v45, v45
  v_exp_f32 v46, v46
  v_exp_f32 v47, v47
  v_cvt_pk_bf16_f32 v96, v40, v41
  v_cvt_pk_bf16_f32 v97, v42, v43
  v_cvt_pk_bf16_f32 v98, v44, v45
  v_cvt_pk_bf16_f32 v99, v46, v47
  s_waitcnt lgkmcnt(2)
  s_nop 1
  v_mfma_f32_32x32x16_bf16 v[64:79], v[88:91], v[96:99], v[64:79]
  ds_read_b128 v[88:91], v6 offset:2560
  s_cbranch_scc0 attn_kernel_pr34
  s_setprio 0
attn_kernel_pr34:
  s_waitcnt lgkmcnt(2)
  v_mfma_f32_32x32x16_bf16 v[32:47], v[80:83], v[100:103], v[48:63]
  ds_read_b128 v[80:83], v4 offset:53248
  v_exp_f32 v16, v16
  v_exp_f32 v17, v17
  v_exp_f32 v18, v18
  v_exp_f32 v19, v19
  v_exp_f32 v20, v20
  v_exp_f32 v21, v21
  v_exp_f32 v22, v22
  v_exp_f32 v23, v23
  v_cvt_pk_bf16_f32 v92, v16, v17
  v_cvt_pk_bf16_f32 v93, v18, v19
  v_cvt_pk_bf16_f32 v94, v20, v21
  v_cvt_pk_bf16_f32 v95, v22, v23
  v_exp_f32 v24, v24
  v_exp_f32 v25, v25
  s_waitcnt lgkmcnt(2)
  v_mfma_f32_32x32x16_bf16 v[64:79], v[84:87], v[92:95], v[64:79]
  ds_read_b128 v[84:87], v6 offset:3072
  v_exp_f32 v26, v26
  v_exp_f32 v27, v27
  v_exp_f32 v28, v28
  v_exp_f32 v29, v29
  v_exp_f32 v30, v30
  v_exp_f32 v31, v31
  v_cvt_pk_bf16_f32 v96, v24, v25
  v_cvt_pk_bf16_f32 v97, v26, v27
  v_cvt_pk_bf16_f32 v98, v28, v29
  v_cvt_pk_bf16_f32 v99, v30, v31
  s_waitcnt lgkmcnt(2)
  s_nop 1
  v_mfma_f32_32x32x16_bf16 v[64:79], v[88:91], v[96:99], v[64:79]
  ds_read_b128 v[88:91], v6 offset:3584
  s_cbranch_scc0 attn_kernel_pr35
  s_setprio 2
attn_kernel_pr35:
  s_waitcnt lgkmcnt(2)
  v_mfma_f32_32x32x16_bf16 v[16:31], v[80:83], v[100:103], v[48:63]
  ds_read_b128 v[80:83], v4 offset:54272
  v_exp_f32 v32, v32
  v_exp_f32 v33, v33
  v_exp_f32 v34, v34
  v_exp_f32 v35, v35
  v_exp_f32 v36, v36
  v_exp_f32 v37, v37
  v_exp_f32 v38, v38
  v_exp_f32 v39, v39
  v_cvt_pk_bf16_f32 v92, v32, v33
  v_cvt_pk_bf16_f32 v93, v34, v35
  v_cvt_pk_bf16_f32 v94, v36, v37
  v_cvt_pk_bf16_f32 v95, v38, v39
  v_exp_f32 v40, v40
  v_exp_f32 v41, v41
  s_waitcnt lgkmcnt(2)
  v_mfma_f32_32x32x16_bf16 v[64:79], v[84:87], v[92:95], v[64:79]
  v_add_u32 v6, v7, v6
  ds_read_b128 v[84:87], v6 offset:0
  v_exp_f32 v42, v42
  v_exp_f32 v43, v43
  v_exp_f32 v44, v44
  v_exp_f32 v45, v45
  v_exp_f32 v46, v46
  v_exp_f32 v47, v47
  v_cvt_pk_bf16_f32 v96, v40, v41
  v_cvt_pk_bf16_f32 v97, v42, v43
  v_cvt_pk_bf16_f32 v98, v44, v45
  v_cvt_pk_bf16_f32 v99, v46, v47
  s_waitcnt lgkmcnt(2)
  s_nop 1
  v_mfma_f32_32x32x16_bf16 v[64:79], v[88:91], v[96:99], v[64:79]
  ds_read_b128 v[88:91], v6 offset:512
  s_waitcnt lgkmcnt(2)
  v_mfma_f32_32x32x16_bf16 v[32:47], v[80:83], v[100:103], v[48:63]
  ds_read_b128 v[80:83], v4 offset:55296
  v_exp_f32 v16, v16
  v_exp_f32 v17, v17
  v_exp_f32 v18, v18
  v_exp_f32 v19, v19
  v_exp_f32 v20, v20
  v_exp_f32 v21, v21
  v_exp_f32 v22, v22
  v_exp_f32 v23, v23
  v_cvt_pk_bf16_f32 v92, v16, v17
  v_cvt_pk_bf16_f32 v93, v18, v19
  v_cvt_pk_bf16_f32 v94, v20, v21
  v_cvt_pk_bf16_f32 v95, v22, v23
  v_exp_f32 v24, v24
  v_exp_f32 v25, v25
  s_waitcnt lgkmcnt(2)
  v_mfma_f32_32x32x16_bf16 v[64:79], v[84:87], v[92:95], v[64:79]
  ds_read_b128 v[84:87], v6 offset:1024
  v_exp_f32 v26, v26
  v_exp_f32 v27, v27
  v_exp_f32 v28, v28
  v_exp_f32 v29, v29
  v_exp_f32 v30, v30
  v_exp_f32 v31, v31
  v_cvt_pk_bf16_f32 v96, v24, v25
  v_cvt_pk_bf16_f32 v97, v26, v27
  v_cvt_pk_bf16_f32 v98, v28, v29
  v_cvt_pk_bf16_f32 v99, v30, v31
  s_waitcnt lgkmcnt(2)
  s_nop 1
  v_mfma_f32_32x32x16_bf16 v[64:79], v[88:91], v[96:99], v[64:79]
  ds_read_b128 v[88:91], v6 offset:1536
  s_cbranch_scc0 attn_kernel_pr36
  s_setprio 0
attn_kernel_pr36:
  s_waitcnt lgkmcnt(2)
  v_mfma_f32_32x32x16_bf16 v[16:31], v[80:83], v[100:103], v[48:63]
  ds_read_b128 v[80:83], v4 offset:56320
  v_exp_f32 v32, v32
  v_exp_f32 v33, v33
  v_exp_f32 v34, v34
  v_exp_f32 v35, v35
  v_exp_f32 v36, v36
  v_exp_f32 v37, v37
  v_exp_f32 v38, v38
  v_exp_f32 v39, v39
  v_cvt_pk_bf16_f32 v92, v32, v33
  v_cvt_pk_bf16_f32 v93, v34, v35
  v_cvt_pk_bf16_f32 v94, v36, v37
  v_cvt_pk_bf16_f32 v95, v38, v39
  v_exp_f32 v40, v40
  v_exp_f32 v41, v41
  s_waitcnt lgkmcnt(2)
  v_mfma_f32_32x32x16_bf16 v[64:79], v[84:87], v[92:95], v[64:79]
  ds_read_b128 v[84:87], v6 offset:2048
  v_exp_f32 v42, v42
  v_exp_f32 v43, v43
  v_exp_f32 v44, v44
  v_exp_f32 v45, v45
  v_exp_f32 v46, v46
  v_exp_f32 v47, v47
  v_cvt_pk_bf16_f32 v96, v40, v41
  v_cvt_pk_bf16_f32 v97, v42, v43
  v_cvt_pk_bf16_f32 v98, v44, v45
  v_cvt_pk_bf16_f32 v99, v46, v47
  s_waitcnt lgkmcnt(2)
  s_nop 1
  v_mfma_f32_32x32x16_bf16 v[64:79], v[88:91], v[96:99], v[64:79]
  ds_read_b128 v[88:91], v6 offset:2560
  s_cbranch_scc0 attn_kernel_pr37
  s_setprio 2
attn_kernel_pr37:
  s_waitcnt lgkmcnt(2)
  v_mfma_f32_32x32x16_bf16 v[32:47], v[80:83], v[100:103], v[48:63]
  ds_read_b128 v[80:83], v4 offset:57344
  v_exp_f32 v16, v16
  v_exp_f32 v17, v17
  v_exp_f32 v18, v18
  v_exp_f32 v19, v19
  v_exp_f32 v20, v20
  v_exp_f32 v21, v21
  v_exp_f32 v22, v22
  v_exp_f32 v23, v23
  v_cvt_pk_bf16_f32 v92, v16, v17
  v_cvt_pk_bf16_f32 v93, v18, v19
  v_cvt_pk_bf16_f32 v94, v20, v21
  v_cvt_pk_bf16_f32 v95, v22, v23
  v_exp_f32 v24, v24
  v_exp_f32 v25, v25
  s_waitcnt lgkmcnt(2)
  v_mfma_f32_32x32x16_bf16 v[64:79], v[84:87], v[92:95], v[64:79]
  ds_read_b128 v[84:87], v6 offset:3072
  v_exp_f32 v26, v26
  v_exp_f32 v27, v27
  v_exp_f32 v28, v28
  v_exp_f32 v29, v29
  v_exp_f32 v30, v30
  v_exp_f32 v31, v31
  v_cvt_pk_bf16_f32 v96, v24, v25
  v_cvt_pk_bf16_f32 v97, v26, v27
  v_cvt_pk_bf16_f32 v98, v28, v29
  v_cvt_pk_bf16_f32 v99, v30, v31
  s_waitcnt lgkmcnt(2)
  s_nop 1
  v_mfma_f32_32x32x16_bf16 v[64:79], v[88:91], v[96:99], v[64:79]
  ds_read_b128 v[88:91], v6 offset:3584
  s_waitcnt lgkmcnt(2)
  v_mfma_f32_32x32x16_bf16 v[16:31], v[80:83], v[100:103], v[48:63]
  ds_read_b128 v[80:83], v4 offset:58368
  v_exp_f32 v32, v32
  v_exp_f32 v33, v33
  v_exp_f32 v34, v34
  v_exp_f32 v35, v35
  v_exp_f32 v36, v36
  v_exp_f32 v37, v37
  v_exp_f32 v38, v38
  v_exp_f32 v39, v39
  v_cvt_pk_bf16_f32 v92, v32, v33
  v_cvt_pk_bf16_f32 v93, v34, v35
  v_cvt_pk_bf16_f32 v94, v36, v37
  v_cvt_pk_bf16_f32 v95, v38, v39
  v_exp_f32 v40, v40
  v_exp_f32 v41, v41
  s_waitcnt lgkmcnt(2)
  v_mfma_f32_32x32x16_bf16 v[64:79], v[84:87], v[92:95], v[64:79]
  v_add_u32 v6, v7, v6
  ds_read_b128 v[84:87], v6 offset:0
  v_exp_f32 v42, v42
  v_exp_f32 v43, v43
  v_exp_f32 v44, v44
  v_exp_f32 v45, v45
  v_exp_f32 v46, v46
  v_exp_f32 v47, v47
  v_cvt_pk_bf16_f32 v96, v40, v41
  v_cvt_pk_bf16_f32 v97, v42, v43
  v_cvt_pk_bf16_f32 v98, v44, v45
  v_cvt_pk_bf16_f32 v99, v46, v47
  s_waitcnt lgkmcnt(2)
  s_nop 1
  v_mfma_f32_32x32x16_bf16 v[64:79], v[88:91], v[96:99], v[64:79]
  ds_read_b128 v[88:91], v6 offset:512
  s_cbranch_scc0 attn_kernel_pr38
  s_setprio 0
attn_kernel_pr38:
  s_waitcnt lgkmcnt(2)
  v_mfma_f32_32x32x16_bf16 v[32:47], v[80:83], v[100:103], v[48:63]
  ds_read_b128 v[80:83], v4 offset:59392
  v_exp_f32 v16, v16
  v_exp_f32 v17, v17
  v_exp_f32 v18, v18
  v_exp_f32 v19, v19
  v_exp_f32 v20, v20
  v_exp_f32 v21, v21
  v_exp_f32 v22, v22
  v_exp_f32 v23, v23
  v_cvt_pk_bf16_f32 v92, v16, v17
  v_cvt_pk_bf16_f32 v93, v18, v19
  v_cvt_pk_bf16_f32 v94, v20, v21
  v_cvt_pk_bf16_f32 v95, v22, v23
  v_exp_f32 v24, v24
  v_exp_f32 v25, v25
  s_waitcnt lgkmcnt(2)
  v_mfma_f32_32x32x16_bf16 v[64:79], v[84:87], v[92:95], v[64:79]
  ds_read_b128 v[84:87], v6 offset:1024
  v_exp_f32 v26, v26
  v_exp_f32 v27, v27
  v_exp_f32 v28, v28
  v_exp_f32 v29, v29
  v_exp_f32 v30, v30
  v_exp_f32 v31, v31
  v_cvt_pk_bf16_f32 v96, v24, v25
  v_cvt_pk_bf16_f32 v97, v26, v27
  v_cvt_pk_bf16_f32 v98, v28, v29
  v_cvt_pk_bf16_f32 v99, v30, v31
  s_waitcnt lgkmcnt(2)
  s_nop 1
  v_mfma_f32_32x32x16_bf16 v[64:79], v[88:91], v[96:99], v[64:79]
  ds_read_b128 v[88:91], v6 offset:1536
  s_cbranch_scc0 attn_kernel_pr39
  s_setprio 2
attn_kernel_pr39:
  s_waitcnt lgkmcnt(2)
  v_mfma_f32_32x32x16_bf16 v[16:31], v[80:83], v[100:103], v[48:63]
  ds_read_b128 v[80:83], v4 offset:60416
  v_exp_f32 v32, v32
  v_exp_f32 v33, v33
  v_exp_f32 v34, v34
  v_exp_f32 v35, v35
  v_exp_f32 v36, v36
  v_exp_f32 v37, v37
  v_exp_f32 v38, v38
  v_exp_f32 v39, v39
  v_cvt_pk_bf16_f32 v92, v32, v33
  v_cvt_pk_bf16_f32 v93, v34, v35
  v_cvt_pk_bf16_f32 v94, v36, v37
  v_cvt_pk_bf16_f32 v95, v38, v39
  v_exp_f32 v40, v40
  v_exp_f32 v41, v41
  s_waitcnt lgkmcnt(2)
  v_mfma_f32_32x32x16_bf16 v[64:79], v[84:87], v[92:95], v[64:79]
  ds_read_b128 v[84:87], v6 offset:2048
  v_exp_f32 v42, v42
  v_exp_f32 v43, v43
  v_exp_f32 v44, v44
  v_exp_f32 v45, v45
  v_exp_f32 v46, v46
  v_exp_f32 v47, v47
  v_cvt_pk_bf16_f32 v96, v40, v41
  v_cvt_pk_bf16_f32 v97, v42, v43
  v_cvt_pk_bf16_f32 v98, v44, v45
  v_cvt_pk_bf16_f32 v99, v46, v47
  s_waitcnt lgkmcnt(2)
  s_nop 1
  v_mfma_f32_32x32x16_bf16 v[64:79], v[88:91], v[96:99], v[64:79]
  ds_read_b128 v[88:91], v6 offset:2560
  s_waitcnt lgkmcnt(2)
  v_mfma_f32_32x32x16_bf16 v[32:47], v[80:83], v[100:103], v[48:63]
  ds_read_b128 v[80:83], v4 offset:61440
  v_exp_f32 v16, v16
  v_exp_f32 v17, v17
  v_exp_f32 v18, v18
  v_exp_f32 v19, v19
  v_exp_f32 v20, v20
  v_exp_f32 v21, v21
  v_exp_f32 v22, v22
  v_exp_f32 v23, v23
  v_cvt_pk_bf16_f32 v92, v16, v17
  v_cvt_pk_bf16_f32 v93, v18, v19
  v_cvt_pk_bf16_f32 v94, v20, v21
  v_cvt_pk_bf16_f32 v95, v22, v23
  v_exp_f32 v24, v24
  v_exp_f32 v25, v25
  s_waitcnt lgkmcnt(2)
  v_mfma_f32_32x32x16_bf16 v[64:79], v[84:87], v[92:95], v[64:79]
  ds_read_b128 v[84:87], v6 offset:3072
  v_exp_f32 v26, v26
  v_exp_f32 v27, v27
  v_exp_f32 v28, v28
  v_exp_f32 v29, v29
  v_exp_f32 v30, v30
  v_exp_f32 v31, v31
  v_cvt_pk_bf16_f32 v96, v24, v25
  v_cvt_pk_bf16_f32 v97, v26, v27
  v_cvt_pk_bf16_f32 v98, v28, v29
  v_cvt_pk_bf16_f32 v99, v30, v31
  s_waitcnt lgkmcnt(2)
  s_nop 1
  v_mfma_f32_32x32x16_bf16 v[64:79], v[88:91], v[96:99], v[64:79]
  ds_read_b128 v[88:91], v6 offset:3584
  s_cbranch_scc0 attn_kernel_pr40
  s_setprio 0
attn_kernel_pr40:
  s_waitcnt lgkmcnt(2)
  v_mfma_f32_32x32x16_bf16 v[16:31], v[80:83], v[100:103], v[48:63]
  ds_read_b128 v[80:83], v4 offset:62464
  v_exp_f32 v32, v32
  v_exp_f32 v33, v33
  v_exp_f32 v34, v34
  v_exp_f32 v35, v35
  v_exp_f32 v36, v36
  v_exp_f32 v37, v37
  v_exp_f32 v38, v38
  v_exp_f32 v39, v39
  v_cvt_pk_bf16_f32 v92, v32, v33
  v_cvt_pk_bf16_f32 v93, v34, v35
  v_cvt_pk_bf16_f32 v94, v36, v37
  v_cvt_pk_bf16_f32 v95, v38, v39
  v_exp_f32 v40, v40
  v_exp_f32 v41, v41
  s_waitcnt lgkmcnt(2)
  v_mfma_f32_32x32x16_bf16 v[64:79], v[84:87], v[92:95], v[64:79]
  v_add_u32 v6, v7, v6
  ds_read_b128 v[84:87], v6 offset:0
  v_exp_f32 v42, v42
  v_exp_f32 v43, v43
  v_exp_f32 v44, v44
  v_exp_f32 v45, v45
  v_exp_f32 v46, v46
  v_exp_f32 v47, v47
  v_cvt_pk_bf16_f32 v96, v40, v41
  v_cvt_pk_bf16_f32 v97, v42, v43
  v_cvt_pk_bf16_f32 v98, v44, v45
  v_cvt_pk_bf16_f32 v99, v46, v47
  s_waitcnt lgkmcnt(2)
  s_nop 1
  v_mfma_f32_32x32x16_bf16 v[64:79], v[88:91], v[96:99], v[64:79]
  ds_read_b128 v[88:91], v6 offset:512
  s_cbranch_scc0 attn_kernel_pr41
  s_setprio 2
attn_kernel_pr41:
  s_waitcnt lgkmcnt(2)
  v_mfma_f32_32x32x16_bf16 v[32:47], v[80:83], v[100:103], v[48:63]
  ds_read_b128 v[80:83], v4 offset:63488
  v_exp_f32 v16, v16
  v_exp_f32 v17, v17
  v_exp_f32 v18, v18
  v_exp_f32 v19, v19
  v_exp_f32 v20, v20
  v_exp_f32 v21, v21
  v_exp_f32 v22, v22
  v_exp_f32 v23, v23
  v_cvt_pk_bf16_f32 v92, v16, v17
  v_cvt_pk_bf16_f32 v93, v18, v19
  v_cvt_pk_bf16_f32 v94, v20, v21
  v_cvt_pk_bf16_f32 v95, v22, v23
  v_exp_f32 v24, v24
  v_exp_f32 v25, v25
  s_waitcnt lgkmcnt(2)
  v_mfma_f32_32x32x16_bf16 v[64:79], v[84:87], v[92:95], v[64:79]
  ds_read_b128 v[84:87], v6 offset:1024
  v_exp_f32 v26, v26
  v_exp_f32 v27, v27
  v_exp_f32 v28, v28
  v_exp_f32 v29, v29
  v_exp_f32 v30, v30
  v_exp_f32 v31, v31
  v_cvt_pk_bf16_f32 v96, v24, v25
  v_cvt_pk_bf16_f32 v97, v26, v27
  v_cvt_pk_bf16_f32 v98, v28, v29
  v_cvt_pk_bf16_f32 v99, v30, v31
  s_waitcnt lgkmcnt(2)
  s_nop 1
  v_mfma_f32_32x32x16_bf16 v[64:79], v[88:91], v[96:99], v[64:79]
  ds_read_b128 v[88:91], v6 offset:1536
  s_waitcnt lgkmcnt(2)
  v_mfma_f32_32x32x16_bf16 v[16:31], v[80:83], v[100:103], v[48:63]
  ds_read_b128 v[80:83], v4 offset:64512
  v_exp_f32 v32, v32
  v_exp_f32 v33, v33
  v_exp_f32 v34, v34
  v_exp_f32 v35, v35
  v_exp_f32 v36, v36
  v_exp_f32 v37, v37
  v_exp_f32 v38, v38
  v_exp_f32 v39, v39
  v_cvt_pk_bf16_f32 v92, v32, v33
  v_cvt_pk_bf16_f32 v93, v34, v35
  v_cvt_pk_bf16_f32 v94, v36, v37
  v_cvt_pk_bf16_f32 v95, v38, v39
  v_exp_f32 v40, v40
  v_exp_f32 v41, v41
  s_waitcnt lgkmcnt(2)
  v_mfma_f32_32x32x16_bf16 v[64:79], v[84:87], v[92:95], v[64:79]
  ds_read_b128 v[84:87], v6 offset:2048
  v_exp_f32 v42, v42
  v_exp_f32 v43, v43
  v_exp_f32 v44, v44
  v_exp_f32 v45, v45
  v_exp_f32 v46, v46
  v_exp_f32 v47, v47
  v_cvt_pk_bf16_f32 v96, v40, v41
  v_cvt_pk_bf16_f32 v97, v42, v43
  v_cvt_pk_bf16_f32 v98, v44, v45
  v_cvt_pk_bf16_f32 v99, v46, v47
  s_waitcnt lgkmcnt(2)
  s_nop 1
  v_mfma_f32_32x32x16_bf16 v[64:79], v[88:91], v[96:99], v[64:79]
  ds_read_b128 v[88:91], v6 offset:2560
  s_cbranch_scc0 attn_kernel_pr42
  s_setprio 0
attn_kernel_pr42:
  s_waitcnt lgkmcnt(2)
  v_mfma_f32_32x32x16_bf16 v[32:47], v[80:83], v[100:103], v[48:63]
  v_exp_f32 v16, v16
  v_exp_f32 v17, v17
  v_exp_f32 v18, v18
  v_exp_f32 v19, v19
  v_exp_f32 v20, v20
  v_exp_f32 v21, v21
  v_exp_f32 v22, v22
  v_exp_f32 v23, v23
  v_cvt_pk_bf16_f32 v92, v16, v17
  v_cvt_pk_bf16_f32 v93, v18, v19
  v_cvt_pk_bf16_f32 v94, v20, v21
  v_cvt_pk_bf16_f32 v95, v22, v23
  v_exp_f32 v24, v24
  v_exp_f32 v25, v25
  s_waitcnt lgkmcnt(1)
  v_mfma_f32_32x32x16_bf16 v[64:79], v[84:87], v[92:95], v[64:79]
  ds_read_b128 v[84:87], v6 offset:3072
  v_exp_f32 v26, v26
  v_exp_f32 v27, v27
  v_exp_f32 v28, v28
  v_exp_f32 v29, v29
  v_exp_f32 v30, v30
  v_exp_f32 v31, v31
  v_cvt_pk_bf16_f32 v96, v24, v25
  v_cvt_pk_bf16_f32 v97, v26, v27
  v_cvt_pk_bf16_f32 v98, v28, v29
  v_cvt_pk_bf16_f32 v99, v30, v31
  s_waitcnt lgkmcnt(1)
  s_nop 1
  v_mfma_f32_32x32x16_bf16 v[64:79], v[88:91], v[96:99], v[64:79]
  ds_read_b128 v[88:91], v6 offset:3584
  s_cbranch_scc0 attn_kernel_pr43
  s_setprio 2
attn_kernel_pr43:
  v_exp_f32 v32, v32
  v_exp_f32 v33, v33
  v_exp_f32 v34, v34
  v_exp_f32 v35, v35
  v_exp_f32 v36, v36
  v_exp_f32 v37, v37
  v_exp_f32 v38, v38
  v_exp_f32 v39, v39
  v_cvt_pk_bf16_f32 v92, v32, v33
  v_cvt_pk_bf16_f32 v93, v34, v35
  v_cvt_pk_bf16_f32 v94, v36, v37
  v_cvt_pk_bf16_f32 v95, v38, v39
  v_exp_f32 v40, v40
  v_exp_f32 v41, v41
  s_waitcnt lgkmcnt(1)
  v_mfma_f32_32x32x16_bf16 v[64:79], v[84:87], v[92:95], v[64:79]
  v_exp_f32 v42, v42
  v_exp_f32 v43, v43
  v_exp_f32 v44, v44
  v_exp_f32 v45, v45
  v_exp_f32 v46, v46
  v_exp_f32 v47, v47
  v_cvt_pk_bf16_f32 v96, v40, v41
  v_cvt_pk_bf16_f32 v97, v42, v43
  v_cvt_pk_bf16_f32 v98, v44, v45
  v_cvt_pk_bf16_f32 v99, v46, v47
  s_waitcnt lgkmcnt(0)
  s_nop 1
  v_mfma_f32_32x32x16_bf16 v[64:79], v[88:91], v[96:99], v[64:79]
  s_nop 13
  v_cmp_ngt_f32 vcc, 0x4f800000, v72
  s_cbranch_vccnz attn_kernel_fb
attn_kernel_fin:
  v_rcp_f32 v8, v72
  s_nop 0
  v_mul_f32 v64, v8, v64
  v_mul_f32 v65, v8, v65
  v_mul_f32 v66, v8, v66
  v_mul_f32 v67, v8, v67
  v_mul_f32 v68, v8, v68
  v_mul_f32 v69, v8, v69
  v_mul_f32 v70, v8, v70
  v_mul_f32 v71, v8, v71
  v_cvt_pk_bf16_f32 v92, v64, v65
  v_cvt_pk_bf16_f32 v93, v66, v67
  v_cvt_pk_bf16_f32 v94, v68, v69
  v_cvt_pk_bf16_f32 v95, v70, v71
  buffer_store_dwordx4 v[92:95], v4, s[12:15], s38 offen
attn_kernel_exit:
  s_endpgm
attn_kernel_fb:
  v_mov_b32 v8, 0xff800000
  v_mov_b32 v10, v4
  s_mov_b32 s40, 0
attn_kernel_fb1:
  ds_read_b128 v[80:83], v10
  v_add_u32 v10, 1024, v10
  s_waitcnt lgkmcnt(0)
  v_mfma_f32_32x32x16_bf16 v[16:31], v[80:83], v[100:103], 0
  s_nop 13
  v_max3_f32 v8, v8, v16, v17
  v_max_f32 v8, v8, v18
  v_max3_f32 v8, v8, v19, v20
  v_max3_f32 v8, v8, v21, v22
  v_max3_f32 v8, v8, v23, v24
  v_max3_f32 v8, v8, v25, v26
  v_max3_f32 v8, v8, v27, v28
  v_max3_f32 v8, v8, v29, v30
  v_max_f32 v8, v8, v31
  s_add_u32 s40, s40, 1
  s_cmp_lt_u32 s40, 64
  s_cbranch_scc1 attn_kernel_fb1
  v_mov_b32 v9, v8
  s_nop 1
  v_permlane32_swap_b32 v8, v9
  s_nop 1
  v_max_f32 v8, v8, v9
  v_sub_f32 v48, 0, v8
  v_sub_f32 v49, 0, v8
  v_sub_f32 v50, 0, v8
  v_sub_f32 v51, 0, v8
  v_sub_f32 v52, 0, v8
  v_sub_f32 v53, 0, v8
  v_sub_f32 v54, 0, v8
  v_sub_f32 v55, 0, v8
  v_sub_f32 v56, 0, v8
  v_sub_f32 v57, 0, v8
  v_sub_f32 v58, 0, v8
  v_sub_f32 v59, 0, v8
  v_sub_f32 v60, 0, v8
  v_sub_f32 v61, 0, v8
  v_sub_f32 v62, 0, v8
  v_sub_f32 v63, 0, v8
  s_nop 1
  v_mov_b32 v64, 0
  v_mov_b32 v65, 0
  v_mov_b32 v66, 0
  v_mov_b32 v67, 0
  v_mov_b32 v68, 0
  v_mov_b32 v69, 0
  v_mov_b32 v70, 0
  v_mov_b32 v71, 0
  v_mov_b32 v72, 0
  v_mov_b32 v73, 0
  v_mov_b32 v74, 0
  v_mov_b32 v75, 0
  v_mov_b32 v76, 0
  v_mov_b32 v77, 0
  v_mov_b32 v78, 0
  v_mov_b32 v79, 0
  v_mov_b32 v10, v4
  v_lshrrev_b32 v11, 2, v7
  s_mov_b32 s40, 0
attn_kernel_fb2:
  ds_read_b128 v[80:83], v10
  ds_read_b128 v[84:87], v5
  ds_read_b128 v[88:91], v5 offset:512
  v_add_u32 v10, 1024, v10
  v_add_u32 v5, v11, v5
  s_waitcnt lgkmcnt(0)
  v_mfma_f32_32x32x16_bf16 v[16:31], v[80:83], v[100:103], v[48:63]
  s_nop 13
  v_exp_f32 v16, v16
  v_exp_f32 v17, v17
  v_exp_f32 v18, v18
  v_exp_f32 v19, v19
  v_exp_f32 v20, v20
  v_exp_f32 v21, v21
  v_exp_f32 v22, v22
  v_exp_f32 v23, v23
  v_exp_f32 v24, v24
  v_exp_f32 v25, v25
  v_exp_f32 v26, v26
  v_exp_f32 v27, v27
  v_exp_f32 v28, v28
  v_exp_f32 v29, v29
  v_exp_f32 v30, v30
  v_exp_f32 v31, v31
  s_nop 0
  v_cvt_pk_bf16_f32 v92, v16, v17
  v_cvt_pk_bf16_f32 v93, v18, v19
  v_cvt_pk_bf16_f32 v94, v20, v21
  v_cvt_pk_bf16_f32 v95, v22, v23
  v_cvt_pk_bf16_f32 v96, v24, v25
  v_cvt_pk_bf16_f32 v97, v26, v27
  v_cvt_pk_bf16_f32 v98, v28, v29
  v_cvt_pk_bf16_f32 v99, v30, v31
  s_nop 1
  v_mfma_f32_32x32x16_bf16 v[64:79], v[84:87], v[92:95], v[64:79]
  v_mfma_f32_32x32x16_bf16 v[64:79], v[88:91], v[96:99], v[64:79]
  s_add_u32 s40, s40, 1
  s_cmp_lt_u32 s40, 64
  s_cbranch_scc1 attn_kernel_fb2
  s_nop 13
  s_branch attn_kernel_fin
.text
.globl outp_kernel
.p2align 8
.type outp_kernel,@function
outp_kernel:
  s_cmp_ge_u32 s2, 256
  s_cbranch_scc1 outp_kernel_exit
  s_load_dwordx2 s[4:5], s[0:1], 64
  s_load_dwordx2 s[6:7], s[0:1], 48
  v_lshrrev_b32 v1, 6, v0
  v_and_b32 v0, 63, v0
  s_and_b32 s28, s2, 7
  v_readfirstlane_b32 s3, v1
  s_lshl_b32 s28, s28, 2
  s_bfe_u32 s29, s2, 0x20003
  s_add_u32 s28, s28, s29
  s_lshr_b32 s29, s2, 5
  v_lshlrev_b32 v4, 4, v0
  s_lshr_b32 s30, s3, 1
  s_and_b32 s31, s3, 1
  s_lshl_b32 s32, s29, 1
  s_add_u32 s33, s32, s30
  s_xor_b32 s34, s33, 1
  s_lshl_b32 s32, s28, 1
  s_add_u32 s35, s32, s31
  s_xor_b32 s36, s35, 1
  s_mul_i32 s37, s3, 8192
  s_mul_i32 s40, s33, 32768
  s_mul_i32 s41, s34, 32768
  s_mul_i32 s42, s35, 32768
  s_mul_i32 s43, s36, 32768
  s_add_u32 s40, s40, s37
  s_add_u32 s41, s41, s37
  s_add_u32 s42, s42, s37
  s_add_u32 s43, s43, s37
  s_waitcnt lgkmcnt(0)

  s_add_u32 s8, s4, 0x1080000
  s_addc_u32 s9, s5, 0
  s_mov_b32 s10, 0x200000
  s_mov_b32 s11, 0x20000
  s_add_u32 s12, s4, 0x360000
  s_addc_u32 s13, s5, 0
  s_mov_b32 s14, 0x80000
  s_mov_b32 s15, 0x20000
  buffer_load_dwordx4 a[0:3], v4, s[12:15], s40 offen offset:0
  buffer_load_dwordx4 a[8:11], v4, s[8:11], s42 offen offset:0
  buffer_load_dwordx4 a[4:7], v4, s[12:15], s41 offen offset:0
  buffer_load_dwordx4 a[12:15], v4, s[8:11], s43 offen offset:0
  buffer_load_dwordx4 a[16:19], v4, s[12:15], s40 offen offset:1024
  buffer_load_dwordx4 a[24:27], v4, s[8:11], s42 offen offset:1024
  buffer_load_dwordx4 a[20:23], v4, s[12:15], s41 offen offset:1024
  buffer_load_dwordx4 a[28:31], v4, s[8:11], s43 offen offset:1024
  buffer_load_dwordx4 a[32:35], v4, s[12:15], s40 offen offset:2048
  buffer_load_dwordx4 a[40:43], v4, s[8:11], s42 offen offset:2048
  buffer_load_dwordx4 a[36:39], v4, s[12:15], s41 offen offset:2048
  buffer_load_dwordx4 a[44:47], v4, s[8:11], s43 offen offset:2048
  buffer_load_dwordx4 a[48:51], v4, s[12:15], s40 offen offset:3072
  buffer_load_dwordx4 a[56:59], v4, s[8:11], s42 offen offset:3072
  buffer_load_dwordx4 a[52:55], v4, s[12:15], s41 offen offset:3072
  buffer_load_dwordx4 a[60:63], v4, s[8:11], s43 offen offset:3072
  s_add_u32 s40, s40, 4096
  s_add_u32 s41, s41, 4096
  s_add_u32 s42, s42, 4096
  s_add_u32 s43, s43, 4096
  buffer_load_dwordx4 a[64:67], v4, s[12:15], s40 offen offset:0
  buffer_load_dwordx4 a[72:75], v4, s[8:11], s42 offen offset:0
  buffer_load_dwordx4 a[68:71], v4, s[12:15], s41 offen offset:0
  buffer_load_dwordx4 a[76:79], v4, s[8:11], s43 offen offset:0
  buffer_load_dwordx4 a[80:83], v4, s[12:15], s40 offen offset:1024
  buffer_load_dwordx4 a[88:91], v4, s[8:11], s42 offen offset:1024
  buffer_load_dwordx4 a[84:87], v4, s[12:15], s41 offen offset:1024
  buffer_load_dwordx4 a[92:95], v4, s[8:11], s43 offen offset:1024
  buffer_load_dwordx4 a[96:99], v4, s[12:15], s40 offen offset:2048
  buffer_load_dwordx4 a[104:107], v4, s[8:11], s42 offen offset:2048
  buffer_load_dwordx4 a[100:103], v4, s[12:15], s41 offen offset:2048
  buffer_load_dwordx4 a[108:111], v4, s[8:11], s43 offen offset:2048
  buffer_load_dwordx4 a[112:115], v4, s[12:15], s40 offen offset:3072
  buffer_load_dwordx4 a[120:123], v4, s[8:11], s42 offen offset:3072
  buffer_load_dwordx4 a[116:119], v4, s[12:15], s41 offen offset:3072
  buffer_load_dwordx4 a[124:127], v4, s[8:11], s43 offen offset:3072
  s_add_u32 s16, s4, 0x600000
  s_addc_u32 s17, s5, 0
  s_mov_b32 s18, 0x200000
  s_mov_b32 s19, 0x20000
  s_lshl_b32 s44, s35, 15
  s_lshl_b32 s45, s33, 11
  s_add_u32 s44, s44, s45
  buffer_load_dwordx4 v[80:83], v4, s[16:19], s44 offen
  buffer_load_dwordx4 v[84:87], v4, s[16:19], s44 offen offset:1024
  v_and_b32 v2, 31, v0
  v_lshrrev_b32 v3, 5, v0
  s_add_u32 s20, s4, 0x840000
  s_addc_u32 s21, s5, 0
  s_mov_b32 s22, 0x200000
  s_mov_b32 s23, 0x20000
  s_add_u32 s24, s4, 0xa40000
  s_addc_u32 s25, s5, 0
  s_mov_b32 s26, 0x40000
  s_mov_b32 s27, 0x20000
  v_lshlrev_b32 v5, 7, v2
  s_lshl_b32 s46, s35, 12
  s_lshl_b32 s45, s33, 3
  s_add_u32 s46, s46, s45

  s_xor_b32 s47, s3, 1
  s_mul_i32 s47, s47, 12288
  s_add_u32 s47, s47, 0
  v_add_u32 v9, s47, v4
  s_xor_b32 s47, s3, 2
  s_mul_i32 s47, s47, 12288
  s_add_u32 s47, s47, 4096
  v_add_u32 v10, s47, v4
  s_xor_b32 s47, s3, 3
  s_mul_i32 s47, s47, 12288
  s_add_u32 s47, s47, 8192
  v_add_u32 v11, s47, v4
  s_mul_i32 s47, s3, 12288
  v_add_u32 v8, s47, v4
  s_waitcnt vmcnt(30)
  v_mfma_f32_32x32x16_bf16 v[16:31], a[0:3], a[8:11], 0
  v_mfma_f32_32x32x16_bf16 v[32:47], a[0:3], a[12:15], 0
  v_mfma_f32_32x32x16_bf16 v[48:63], a[4:7], a[8:11], 0
  v_mfma_f32_32x32x16_bf16 v[64:79], a[4:7], a[12:15], 0
  s_waitcnt vmcnt(26)
  v_mfma_f32_32x32x16_bf16 v[16:31], a[16:19], a[24:27], v[16:31]
  v_mfma_f32_32x32x16_bf16 v[32:47], a[16:19], a[28:31], v[32:47]
  v_mfma_f32_32x32x16_bf16 v[48:63], a[20:23], a[24:27], v[48:63]
  v_mfma_f32_32x32x16_bf16 v[64:79], a[20:23], a[28:31], v[64:79]
  s_waitcnt vmcnt(22)
  v_mfma_f32_32x32x16_bf16 v[16:31], a[32:35], a[40:43], v[16:31]
  v_mfma_f32_32x32x16_bf16 v[32:47], a[32:35], a[44:47], v[32:47]
  v_mfma_f32_32x32x16_bf16 v[48:63], a[36:39], a[40:43], v[48:63]
  v_mfma_f32_32x32x16_bf16 v[64:79], a[36:39], a[44:47], v[64:79]
  s_waitcnt vmcnt(18)
  v_mfma_f32_32x32x16_bf16 v[16:31], a[48:51], a[56:59], v[16:31]
  v_mfma_f32_32x32x16_bf16 v[32:47], a[48:51], a[60:63], v[32:47]
  v_mfma_f32_32x32x16_bf16 v[48:63], a[52:55], a[56:59], v[48:63]
  v_mfma_f32_32x32x16_bf16 v[64:79], a[52:55], a[60:63], v[64:79]
  s_waitcnt vmcnt(14)
  v_mfma_f32_32x32x16_bf16 v[16:31], a[64:67], a[72:75], v[16:31]
  v_mfma_f32_32x32x16_bf16 v[32:47], a[64:67], a[76:79], v[32:47]
  v_mfma_f32_32x32x16_bf16 v[48:63], a[68:71], a[72:75], v[48:63]
  v_mfma_f32_32x32x16_bf16 v[64:79], a[68:71], a[76:79], v[64:79]
  s_waitcnt vmcnt(10)
  v_mfma_f32_32x32x16_bf16 v[16:31], a[80:83], a[88:91], v[16:31]
  v_mfma_f32_32x32x16_bf16 v[32:47], a[80:83], a[92:95], v[32:47]
  v_mfma_f32_32x32x16_bf16 v[48:63], a[84:87], a[88:91], v[48:63]
  v_mfma_f32_32x32x16_bf16 v[64:79], a[84:87], a[92:95], v[64:79]
  s_waitcnt vmcnt(6)
  v_mfma_f32_32x32x16_bf16 v[16:31], a[96:99], a[104:107], v[16:31]
  v_mfma_f32_32x32x16_bf16 v[32:47], a[96:99], a[108:111], v[32:47]
  v_mfma_f32_32x32x16_bf16 v[48:63], a[100:103], a[104:107], v[48:63]
  v_mfma_f32_32x32x16_bf16 v[64:79], a[100:103], a[108:111], v[64:79]
  s_waitcnt vmcnt(2)
  v_mfma_f32_32x32x16_bf16 v[16:31], a[112:115], a[120:123], v[16:31]
  v_mfma_f32_32x32x16_bf16 v[32:47], a[112:115], a[124:127], v[32:47]
  v_mfma_f32_32x32x16_bf16 v[48:63], a[116:119], a[120:123], v[48:63]
  v_mfma_f32_32x32x16_bf16 v[64:79], a[116:119], a[124:127], v[64:79]
  s_nop 9
  ds_write_b128 v9, v[32:35] offset:0
  ds_write_b128 v9, v[36:39] offset:1024
  ds_write_b128 v9, v[40:43] offset:2048
  ds_write_b128 v9, v[44:47] offset:3072
  ds_write_b128 v10, v[48:51] offset:0
  ds_write_b128 v10, v[52:55] offset:1024
  ds_write_b128 v10, v[56:59] offset:2048
  ds_write_b128 v10, v[60:63] offset:3072
  s_nop 3
  ds_write_b128 v11, v[64:67] offset:0
  ds_write_b128 v11, v[68:71] offset:1024
  ds_write_b128 v11, v[72:75] offset:2048
  ds_write_b128 v11, v[76:79] offset:3072
  s_waitcnt lgkmcnt(0)
  s_barrier
  ds_read_b128 v[32:35], v8 offset:0
  ds_read_b128 v[36:39], v8 offset:1024
  ds_read_b128 v[40:43], v8 offset:2048
  ds_read_b128 v[44:47], v8 offset:3072
  ds_read_b128 v[48:51], v8 offset:4096
  ds_read_b128 v[52:55], v8 offset:5120
  ds_read_b128 v[56:59], v8 offset:6144
  ds_read_b128 v[60:63], v8 offset:7168
  ds_read_b128 v[64:67], v8 offset:8192
  ds_read_b128 v[68:71], v8 offset:9216
  ds_read_b128 v[72:75], v8 offset:10240
  ds_read_b128 v[76:79], v8 offset:11264
  s_waitcnt vmcnt(0)
  v_lshlrev_b32 v96, 16, v80
  v_and_b32 v97, 0xffff0000, v80
  v_add_f32 v16, v16, v96
  v_add_f32 v17, v17, v97
  v_lshlrev_b32 v96, 16, v81
  v_and_b32 v97, 0xffff0000, v81
  v_add_f32 v18, v18, v96
  v_add_f32 v19, v19, v97
  v_lshlrev_b32 v96, 16, v82
  v_and_b32 v97, 0xffff0000, v82
  v_add_f32 v20, v20, v96
  v_add_f32 v21, v21, v97
  v_lshlrev_b32 v96, 16, v83
  v_and_b32 v97, 0xffff0000, v83
  v_add_f32 v22, v22, v96
  v_add_f32 v23, v23, v97
  v_lshlrev_b32 v96, 16, v84
  v_and_b32 v97, 0xffff0000, v84
  v_add_f32 v24, v24, v96
  v_add_f32 v25, v25, v97
  v_lshlrev_b32 v96, 16, v85
  v_and_b32 v97, 0xffff0000, v85
  v_add_f32 v26, v26, v96
  v_add_f32 v27, v27, v97
  v_lshlrev_b32 v96, 16, v86
  v_and_b32 v97, 0xffff0000, v86
  v_add_f32 v28, v28, v96
  v_add_f32 v29, v29, v97
  v_lshlrev_b32 v96, 16, v87
  v_and_b32 v97, 0xffff0000, v87
  v_add_f32 v30, v30, v96
  v_add_f32 v31, v31, v97
  s_waitcnt lgkmcnt(8)
  v_add_f32 v16, v16, v32
  v_add_f32 v17, v17, v33
  v_add_f32 v18, v18, v34
  v_add_f32 v19, v19, v35
  v_add_f32 v20, v20, v36
  v_add_f32 v21, v21, v37
  v_add_f32 v22, v22, v38
  v_add_f32 v23, v23, v39
  v_add_f32 v24, v24, v40
  v_add_f32 v25, v25, v41
  v_add_f32 v26, v26, v42
  v_add_f32 v27, v27, v43
  v_add_f32 v28, v28, v44
  v_add_f32 v29, v29, v45
  v_add_f32 v30, v30, v46
  v_add_f32 v31, v31, v47
  s_waitcnt lgkmcnt(4)
  v_add_f32 v16, v16, v48
  v_add_f32 v17, v17, v49
  v_add_f32 v18, v18, v50
  v_add_f32 v19, v19, v51
  v_add_f32 v20, v20, v52
  v_add_f32 v21, v21, v53
  v_add_f32 v22, v22, v54
  v_add_f32 v23, v23, v55
  v_add_f32 v24, v24, v56
  v_add_f32 v25, v25, v57
  v_add_f32 v26, v26, v58
  v_add_f32 v27, v27, v59
  v_add_f32 v28, v28, v60
  v_add_f32 v29, v29, v61
  v_add_f32 v30, v30, v62
  v_add_f32 v31, v31, v63
  s_waitcnt lgkmcnt(0)
  v_add_f32 v16, v16, v64
  v_add_f32 v17, v17, v65
  v_add_f32 v18, v18, v66
  v_add_f32 v19, v19, v67
  v_add_f32 v20, v20, v68
  v_add_f32 v21, v21, v69
  v_add_f32 v22, v22, v70
  v_add_f32 v23, v23, v71
  v_add_f32 v24, v24, v72
  v_add_f32 v25, v25, v73
  v_add_f32 v26, v26, v74
  v_add_f32 v27, v27, v75
  v_add_f32 v28, v28, v76
  v_add_f32 v29, v29, v77
  v_add_f32 v30, v30, v78
  v_add_f32 v31, v31, v79
  v_cvt_pk_bf16_f32 v88, v16, v17
  v_cvt_pk_bf16_f32 v89, v18, v19
  v_cvt_pk_bf16_f32 v90, v20, v21
  v_cvt_pk_bf16_f32 v91, v22, v23
  v_cvt_pk_bf16_f32 v92, v24, v25
  v_cvt_pk_bf16_f32 v93, v26, v27
  v_cvt_pk_bf16_f32 v94, v28, v29
  v_cvt_pk_bf16_f32 v95, v30, v31
  buffer_store_dwordx4 v[88:91], v4, s[20:23], s44 offen sc1
  buffer_store_dwordx4 v[92:95], v4, s[20:23], s44 offen offset:1024 sc1
  v_mov_b32 v12, 0
  v_mov_b32 v13, 0
  s_mov_b32 s47, 0x3f803f80
  v_dot2_f32_bf16 v12, v88, s47, v12
  v_dot2_f32_bf16 v13, v88, v88, v13
  v_dot2_f32_bf16 v12, v89, s47, v12
  v_dot2_f32_bf16 v13, v89, v89, v13
  v_dot2_f32_bf16 v12, v90, s47, v12
  v_dot2_f32_bf16 v13, v90, v90, v13
  v_dot2_f32_bf16 v12, v91, s47, v12
  v_dot2_f32_bf16 v13, v91, v91, v13
  v_dot2_f32_bf16 v12, v92, s47, v12
  v_dot2_f32_bf16 v13, v92, v92, v13
  v_dot2_f32_bf16 v12, v93, s47, v12
  v_dot2_f32_bf16 v13, v93, v93, v13
  v_dot2_f32_bf16 v12, v94, s47, v12
  v_dot2_f32_bf16 v13, v94, v94, v13
  v_dot2_f32_bf16 v12, v95, s47, v12
  v_dot2_f32_bf16 v13, v95, v95, v13
  s_nop 3
  v_mov_b32 v14, v12
  v_mov_b32 v15, v13
  s_nop 1
  v_permlane32_swap_b32 v12, v14
  v_permlane32_swap_b32 v13, v15
  s_nop 1
  v_add_f32 v12, v12, v14
  v_add_f32 v13, v13, v15
  buffer_store_dwordx2 v[12:13], v5, s[24:27], s46 offen

outp_kernel_exit:
  s_endpgm
.text
.globl ffn1_kernel
.p2align 8
.type ffn1_kernel,@function
ffn1_kernel:
  s_cmp_ge_u32 s2, 224
  s_cbranch_scc1 ffn1_kernel_pfx
  s_load_dwordx2 s[4:5], s[0:1], 64
  v_lshrrev_b32 v1, 6, v0
  v_and_b32 v0, 63, v0
  s_and_b32 s28, s2, 7
  v_readfirstlane_b32 s3, v1
  s_lshl_b32 s28, s28, 1
  s_bfe_u32 s29, s2, 0x10003
  s_add_u32 s28, s28, s29
  s_lshr_b32 s29, s2, 4
  s_lshl_b32 s28, s28, 2
  s_add_u32 s28, s28, s3
  v_and_b32 v2, 31, v0
  v_lshrrev_b32 v3, 5, v0
  v_lshlrev_b32 v4, 4, v0
  v_lshlrev_b32 v5, 7, v2
  v_lshl_add_u32 v5, v3, 6, v5
  s_lshl_b32 s30, s28, 12
  s_lshl_b32 s31, s28, 15
  s_waitcnt lgkmcnt(0)

  s_add_u32 s16, s4, 0x190000
  s_addc_u32 s17, s5, 0
  s_mov_b32 s18, 0x1c0000
  s_mov_b32 s19, 0x20000
  s_lshl_b32 s32, s29, 2
  s_add_u32 s32, s32, 0
  s_lshl_b32 s33, s29, 2
  s_add_u32 s33, s33, 1
  s_lshl_b32 s34, s29, 2
  s_add_u32 s34, s34, 2
  s_lshl_b32 s35, s29, 2
  s_add_u32 s35, s35, 3
  s_lshl_b32 s37, s3, 11
  s_lshl_b32 s48, s32, 15
  s_add_u32 s48, s48, s37
  s_lshl_b32 s49, s33, 15
  s_add_u32 s49, s49, s37
  s_lshl_b32 s50, s34, 15
  s_add_u32 s50, s50, s37
  s_lshl_b32 s51, s35, 15
  s_add_u32 s51, s51, s37
  s_add_u32 m0, s37, 0
  s_add_u32 s36, s48, 0
  buffer_load_dwordx4 v4, s[16:19], s36 offen lds
  buffer_load_dwordx4 v4, s[16:19], s36 offen offset:1024 lds
  s_add_u32 m0, s37, 32768
  s_add_u32 s36, s49, 0
  buffer_load_dwordx4 v4, s[16:19], s36 offen lds
  buffer_load_dwordx4 v4, s[16:19], s36 offen offset:1024 lds
  s_add_u32 m0, s37, 65536
  s_add_u32 s36, s50, 0
  buffer_load_dwordx4 v4, s[16:19], s36 offen lds
  buffer_load_dwordx4 v4, s[16:19], s36 offen offset:1024 lds
  s_add_u32 m0, s37, 98304
  s_add_u32 s36, s51, 0
  buffer_load_dwordx4 v4, s[16:19], s36 offen lds
  buffer_load_dwordx4 v4, s[16:19], s36 offen offset:1024 lds
  s_add_u32 s8, s4, 0x840000
  s_addc_u32 s9, s5, 0
  s_mov_b32 s10, 0x200000
  s_mov_b32 s11, 0x20000
  buffer_load_dwordx4 a[0:3], v4, s[8:11], s31 offen offset:0
  buffer_load_dwordx4 a[4:7], v4, s[8:11], s31 offen offset:1024
  buffer_load_dwordx4 a[8:11], v4, s[8:11], s31 offen offset:2048
  buffer_load_dwordx4 a[12:15], v4, s[8:11], s31 offen offset:3072
  s_add_u32 s31, s31, 4096
  buffer_load_dwordx4 a[16:19], v4, s[8:11], s31 offen offset:0
  buffer_load_dwordx4 a[20:23], v4, s[8:11], s31 offen offset:1024
  buffer_load_dwordx4 a[24:27], v4, s[8:11], s31 offen offset:2048
  buffer_load_dwordx4 a[28:31], v4, s[8:11], s31 offen offset:3072
  s_add_u32 m0, s37, 8192
  s_add_u32 s36, s48, 8192
  buffer_load_dwordx4 v4, s[16:19], s36 offen lds
  buffer_load_dwordx4 v4, s[16:19], s36 offen offset:1024 lds
  s_add_u32 m0, s37, 40960
  s_add_u32 s36, s49, 8192
  buffer_load_dwordx4 v4, s[16:19], s36 offen lds
  buffer_load_dwordx4 v4, s[16:19], s36 offen offset:1024 lds
  s_add_u32 m0, s37, 73728
  s_add_u32 s36, s50, 8192
  buffer_load_dwordx4 v4, s[16:19], s36 offen lds
  buffer_load_dwordx4 v4, s[16:19], s36 offen offset:1024 lds
  s_add_u32 m0, s37, 106496
  s_add_u32 s36, s51, 8192
  buffer_load_dwordx4 v4, s[16:19], s36 offen lds
  buffer_load_dwordx4 v4, s[16:19], s36 offen offset:1024 lds
  s_add_u32 s31, s31, 4096
  buffer_load_dwordx4 a[32:35], v4, s[8:11], s31 offen offset:0
  buffer_load_dwordx4 a[36:39], v4, s[8:11], s31 offen offset:1024
  buffer_load_dwordx4 a[40:43], v4, s[8:11], s31 offen offset:2048
  buffer_load_dwordx4 a[44:47], v4, s[8:11], s31 offen offset:3072
  s_add_u32 s31, s31, 4096
  buffer_load_dwordx4 a[48:51], v4, s[8:11], s31 offen offset:0
  buffer_load_dwordx4 a[52:55], v4, s[8:11], s31 offen offset:1024
  buffer_load_dwordx4 a[56:59], v4, s[8:11], s31 offen offset:2048
  buffer_load_dwordx4 a[60:63], v4, s[8:11], s31 offen offset:3072
  s_add_u32 s12, s4, 0xa40000
  s_addc_u32 s13, s5, 0
  s_mov_b32 s14, 0x40000
  s_mov_b32 s15, 0x20000
  s_add_u32 s20, s4, 0x350000
  s_addc_u32 s21, s5, 0
  s_mov_b32 s22, 0xe000
  s_mov_b32 s23, 0x20000
  s_add_u32 s24, s4, 0x1280000
  s_addc_u32 s25, s5, 0
  s_mov_b32 s26, 0x700000
  s_mov_b32 s27, 0x20000
  s_mul_i32 s40, s28, 114688
  s_lshl_b32 s41, s29, 13
  s_add_u32 s40, s40, s41
  v_add_u32 v13, 0x10000, v4
  s_waitcnt vmcnt(24)
  s_barrier
  ds_read_b128 v[80:83], v4 offset:0
  ds_read_b128 v[84:87], v4 offset:32768
  ds_read_b128 v[88:91], v13 offset:0
  ds_read_b128 v[92:95], v13 offset:32768
  ds_read_b128 v[96:99], v4 offset:1024
  ds_read_b128 v[100:103], v4 offset:33792
  ds_read_b128 v[104:107], v13 offset:1024
  ds_read_b128 v[108:111], v13 offset:33792
  s_waitcnt vmcnt(23)
  s_waitcnt lgkmcnt(4)
  v_mfma_f32_32x32x16_bf16 v[16:31], v[80:83], a[0:3], 0
  ds_read_b128 v[80:83], v4 offset:2048
  s_add_u32 m0, s37, 16384
  s_add_u32 s36, s48, 16384
  buffer_load_dwordx4 v4, s[16:19], s36 offen lds
  v_mfma_f32_32x32x16_bf16 v[32:47], v[84:87], a[0:3], 0
  ds_read_b128 v[84:87], v4 offset:34816
  buffer_load_dwordx4 v4, s[16:19], s36 offen offset:1024 lds
  v_mfma_f32_32x32x16_bf16 v[48:63], v[88:91], a[0:3], 0
  ds_read_b128 v[88:91], v13 offset:2048
  s_add_u32 m0, s37, 49152
  s_add_u32 s36, s49, 16384
  buffer_load_dwordx4 v4, s[16:19], s36 offen lds
  v_mfma_f32_32x32x16_bf16 v[64:79], v[92:95], a[0:3], 0
  ds_read_b128 v[92:95], v13 offset:34816
  buffer_load_dwordx4 v4, s[16:19], s36 offen offset:1024 lds
  s_waitcnt vmcnt(26)
  s_waitcnt lgkmcnt(4)
  v_mfma_f32_32x32x16_bf16 v[16:31], v[96:99], a[4:7], v[16:31]
  ds_read_b128 v[96:99], v4 offset:3072
  s_add_u32 m0, s37, 81920
  s_add_u32 s36, s50, 16384
  buffer_load_dwordx4 v4, s[16:19], s36 offen lds
  v_mfma_f32_32x32x16_bf16 v[32:47], v[100:103], a[4:7], v[32:47]
  ds_read_b128 v[100:103], v4 offset:35840
  buffer_load_dwordx4 v4, s[16:19], s36 offen offset:1024 lds
  v_mfma_f32_32x32x16_bf16 v[48:63], v[104:107], a[4:7], v[48:63]
  ds_read_b128 v[104:107], v13 offset:3072
  s_add_u32 m0, s37, 114688
  s_add_u32 s36, s51, 16384
  buffer_load_dwordx4 v4, s[16:19], s36 offen lds
  v_mfma_f32_32x32x16_bf16 v[64:79], v[108:111], a[4:7], v[64:79]
  ds_read_b128 v[108:111], v13 offset:35840
  buffer_load_dwordx4 v4, s[16:19], s36 offen offset:1024 lds
  s_waitcnt vmcnt(29)
  s_waitcnt lgkmcnt(4)
  v_mfma_f32_32x32x16_bf16 v[16:31], v[80:83], a[8:11], v[16:31]
  ds_read_b128 v[80:83], v4 offset:4096
  s_add_u32 s31, s31, 4096
  buffer_load_dwordx4 a[64:67], v4, s[8:11], s31 offen offset:0
  v_mfma_f32_32x32x16_bf16 v[32:47], v[84:87], a[8:11], v[32:47]
  ds_read_b128 v[84:87], v4 offset:36864
  buffer_load_dwordx4 a[68:71], v4, s[8:11], s31 offen offset:1024
  v_mfma_f32_32x32x16_bf16 v[48:63], v[88:91], a[8:11], v[48:63]
  ds_read_b128 v[88:91], v13 offset:4096
  buffer_load_dwordx4 a[72:75], v4, s[8:11], s31 offen offset:2048
  v_mfma_f32_32x32x16_bf16 v[64:79], v[92:95], a[8:11], v[64:79]
  ds_read_b128 v[92:95], v13 offset:36864
  buffer_load_dwordx4 a[76:79], v4, s[8:11], s31 offen offset:3072
  s_waitcnt vmcnt(32)
  s_waitcnt lgkmcnt(4)
  v_mfma_f32_32x32x16_bf16 v[16:31], v[96:99], a[12:15], v[16:31]
  ds_read_b128 v[96:99], v4 offset:5120
  s_add_u32 s31, s31, 4096
  buffer_load_dwordx4 a[80:83], v4, s[8:11], s31 offen offset:0
  v_mfma_f32_32x32x16_bf16 v[32:47], v[100:103], a[12:15], v[32:47]
  ds_read_b128 v[100:103], v4 offset:37888
  buffer_load_dwordx4 a[84:87], v4, s[8:11], s31 offen offset:1024
  v_mfma_f32_32x32x16_bf16 v[48:63], v[104:107], a[12:15], v[48:63]
  ds_read_b128 v[104:107], v13 offset:5120
  buffer_load_dwordx4 a[88:91], v4, s[8:11], s31 offen offset:2048
  v_mfma_f32_32x32x16_bf16 v[64:79], v[108:111], a[12:15], v[64:79]
  ds_read_b128 v[108:111], v13 offset:37888
  buffer_load_dwordx4 a[92:95], v4, s[8:11], s31 offen offset:3072
  s_waitcnt vmcnt(35)
  s_waitcnt lgkmcnt(4)
  v_mfma_f32_32x32x16_bf16 v[16:31], v[80:83], a[16:19], v[16:31]
  ds_read_b128 v[80:83], v4 offset:6144
  buffer_load_dwordx4 v[128:131], v5, s[12:15], s30 offen offset:0
  v_mfma_f32_32x32x16_bf16 v[32:47], v[84:87], a[16:19], v[32:47]
  ds_read_b128 v[84:87], v4 offset:38912
  buffer_load_dwordx4 v[132:135], v5, s[12:15], s30 offen offset:16
  v_mfma_f32_32x32x16_bf16 v[48:63], v[88:91], a[16:19], v[48:63]
  ds_read_b128 v[88:91], v13 offset:6144
  buffer_load_dwordx4 v[136:139], v5, s[12:15], s30 offen offset:32
  v_mfma_f32_32x32x16_bf16 v[64:79], v[92:95], a[16:19], v[64:79]
  ds_read_b128 v[92:95], v13 offset:38912
  buffer_load_dwordx4 v[140:143], v5, s[12:15], s30 offen offset:48
  s_waitcnt vmcnt(38)
  s_waitcnt lgkmcnt(4)
  v_mfma_f32_32x32x16_bf16 v[16:31], v[96:99], a[20:23], v[16:31]
  ds_read_b128 v[96:99], v4 offset:7168
  v_mfma_f32_32x32x16_bf16 v[32:47], v[100:103], a[20:23], v[32:47]
  ds_read_b128 v[100:103], v4 offset:39936
  v_mfma_f32_32x32x16_bf16 v[48:63], v[104:107], a[20:23], v[48:63]
  ds_read_b128 v[104:107], v13 offset:7168
  v_mfma_f32_32x32x16_bf16 v[64:79], v[108:111], a[20:23], v[64:79]
  ds_read_b128 v[108:111], v13 offset:39936
  s_waitcnt vmcnt(37)
  s_waitcnt lgkmcnt(4)
  v_mfma_f32_32x32x16_bf16 v[16:31], v[80:83], a[24:27], v[16:31]
  s_waitcnt vmcnt(28)
  s_barrier
  ds_read_b128 v[80:83], v4 offset:8192
  v_mfma_f32_32x32x16_bf16 v[32:47], v[84:87], a[24:27], v[32:47]
  ds_read_b128 v[84:87], v4 offset:40960
  v_mfma_f32_32x32x16_bf16 v[48:63], v[88:91], a[24:27], v[48:63]
  ds_read_b128 v[88:91], v13 offset:8192
  v_mfma_f32_32x32x16_bf16 v[64:79], v[92:95], a[24:27], v[64:79]
  ds_read_b128 v[92:95], v13 offset:40960
  s_waitcnt lgkmcnt(4)
  v_mfma_f32_32x32x16_bf16 v[16:31], v[96:99], a[28:31], v[16:31]
  ds_read_b128 v[96:99], v4 offset:9216
  v_mfma_f32_32x32x16_bf16 v[32:47], v[100:103], a[28:31], v[32:47]
  ds_read_b128 v[100:103], v4 offset:41984
  v_mfma_f32_32x32x16_bf16 v[48:63], v[104:107], a[28:31], v[48:63]
  ds_read_b128 v[104:107], v13 offset:9216
  v_mfma_f32_32x32x16_bf16 v[64:79], v[108:111], a[28:31], v[64:79]
  ds_read_b128 v[108:111], v13 offset:41984
  s_waitcnt vmcnt(27)
  s_waitcnt lgkmcnt(4)
  v_mfma_f32_32x32x16_bf16 v[16:31], v[80:83], a[32:35], v[16:31]
  ds_read_b128 v[80:83], v4 offset:10240
  s_add_u32 m0, s37, 24576
  s_add_u32 s36, s48, 24576
  buffer_load_dwordx4 v4, s[16:19], s36 offen lds
  v_mfma_f32_32x32x16_bf16 v[32:47], v[84:87], a[32:35], v[32:47]
  ds_read_b128 v[84:87], v4 offset:43008
  buffer_load_dwordx4 v4, s[16:19], s36 offen offset:1024 lds
  v_mfma_f32_32x32x16_bf16 v[48:63], v[88:91], a[32:35], v[48:63]
  ds_read_b128 v[88:91], v13 offset:10240
  s_add_u32 m0, s37, 57344
  s_add_u32 s36, s49, 24576
  buffer_load_dwordx4 v4, s[16:19], s36 offen lds
  v_mfma_f32_32x32x16_bf16 v[64:79], v[92:95], a[32:35], v[64:79]
  ds_read_b128 v[92:95], v13 offset:43008
  buffer_load_dwordx4 v4, s[16:19], s36 offen offset:1024 lds
  s_waitcnt vmcnt(30)
  s_waitcnt lgkmcnt(4)
  v_mfma_f32_32x32x16_bf16 v[16:31], v[96:99], a[36:39], v[16:31]
  ds_read_b128 v[96:99], v4 offset:11264
  s_add_u32 m0, s37, 90112
  s_add_u32 s36, s50, 24576
  buffer_load_dwordx4 v4, s[16:19], s36 offen lds
  v_mfma_f32_32x32x16_bf16 v[32:47], v[100:103], a[36:39], v[32:47]
  ds_read_b128 v[100:103], v4 offset:44032
  buffer_load_dwordx4 v4, s[16:19], s36 offen offset:1024 lds
  v_mfma_f32_32x32x16_bf16 v[48:63], v[104:107], a[36:39], v[48:63]
  ds_read_b128 v[104:107], v13 offset:11264
  s_add_u32 m0, s37, 122880
  s_add_u32 s36, s51, 24576
  buffer_load_dwordx4 v4, s[16:19], s36 offen lds
  v_mfma_f32_32x32x16_bf16 v[64:79], v[108:111], a[36:39], v[64:79]
  ds_read_b128 v[108:111], v13 offset:44032
  buffer_load_dwordx4 v4, s[16:19], s36 offen offset:1024 lds
  s_waitcnt vmcnt(33)
  s_waitcnt lgkmcnt(4)
  v_mfma_f32_32x32x16_bf16 v[16:31], v[80:83], a[40:43], v[16:31]
  ds_read_b128 v[80:83], v4 offset:12288
  s_add_u32 s31, s31, 4096
  buffer_load_dwordx4 a[96:99], v4, s[8:11], s31 offen offset:0
  v_mfma_f32_32x32x16_bf16 v[32:47], v[84:87], a[40:43], v[32:47]
  ds_read_b128 v[84:87], v4 offset:45056
  buffer_load_dwordx4 a[100:103], v4, s[8:11], s31 offen offset:1024
  v_mfma_f32_32x32x16_bf16 v[48:63], v[88:91], a[40:43], v[48:63]
  ds_read_b128 v[88:91], v13 offset:12288
  buffer_load_dwordx4 a[104:107], v4, s[8:11], s31 offen offset:2048
  v_mfma_f32_32x32x16_bf16 v[64:79], v[92:95], a[40:43], v[64:79]
  ds_read_b128 v[92:95], v13 offset:45056
  buffer_load_dwordx4 a[108:111], v4, s[8:11], s31 offen offset:3072
  s_waitcnt vmcnt(36)
  s_waitcnt lgkmcnt(4)
  v_mfma_f32_32x32x16_bf16 v[16:31], v[96:99], a[44:47], v[16:31]
  ds_read_b128 v[96:99], v4 offset:13312
  s_add_u32 s31, s31, 4096
  buffer_load_dwordx4 a[112:115], v4, s[8:11], s31 offen offset:0
  v_mfma_f32_32x32x16_bf16 v[32:47], v[100:103], a[44:47], v[32:47]
  ds_read_b128 v[100:103], v4 offset:46080
  buffer_load_dwordx4 a[116:119], v4, s[8:11], s31 offen offset:1024
  v_mfma_f32_32x32x16_bf16 v[48:63], v[104:107], a[44:47], v[48:63]
  ds_read_b128 v[104:107], v13 offset:13312
  buffer_load_dwordx4 a[120:123], v4, s[8:11], s31 offen offset:2048
  v_mfma_f32_32x32x16_bf16 v[64:79], v[108:111], a[44:47], v[64:79]
  ds_read_b128 v[108:111], v13 offset:46080
  buffer_load_dwordx4 a[124:127], v4, s[8:11], s31 offen offset:3072
  s_waitcnt vmcnt(39)
  s_waitcnt lgkmcnt(4)
  v_mfma_f32_32x32x16_bf16 v[16:31], v[80:83], a[48:51], v[16:31]
  ds_read_b128 v[80:83], v4 offset:14336
  s_lshl_b32 s36, s32, 10
  buffer_load_dwordx4 v[112:115], v4, s[20:23], s36 offen
  v_mfma_f32_32x32x16_bf16 v[32:47], v[84:87], a[48:51], v[32:47]
  ds_read_b128 v[84:87], v4 offset:47104
  s_lshl_b32 s36, s33, 10
  buffer_load_dwordx4 v[116:119], v4, s[20:23], s36 offen
  v_mfma_f32_32x32x16_bf16 v[48:63], v[88:91], a[48:51], v[48:63]
  ds_read_b128 v[88:91], v13 offset:14336
  s_lshl_b32 s36, s34, 10
  buffer_load_dwordx4 v[120:123], v4, s[20:23], s36 offen
  v_mfma_f32_32x32x16_bf16 v[64:79], v[92:95], a[48:51], v[64:79]
  ds_read_b128 v[92:95], v13 offset:47104
  s_lshl_b32 s36, s35, 10
  buffer_load_dwordx4 v[124:127], v4, s[20:23], s36 offen
  s_waitcnt vmcnt(42)
  s_waitcnt lgkmcnt(4)
  v_mfma_f32_32x32x16_bf16 v[16:31], v[96:99], a[52:55], v[16:31]
  ds_read_b128 v[96:99], v4 offset:15360
  v_mfma_f32_32x32x16_bf16 v[32:47], v[100:103], a[52:55], v[32:47]
  ds_read_b128 v[100:103], v4 offset:48128
  v_mfma_f32_32x32x16_bf16 v[48:63], v[104:107], a[52:55], v[48:63]
  ds_read_b128 v[104:107], v13 offset:15360
  v_mfma_f32_32x32x16_bf16 v[64:79], v[108:111], a[52:55], v[64:79]
  ds_read_b128 v[108:111], v13 offset:48128
  s_waitcnt vmcnt(41)
  s_waitcnt lgkmcnt(4)
  v_mfma_f32_32x32x16_bf16 v[16:31], v[80:83], a[56:59], v[16:31]
  s_waitcnt vmcnt(32)
  s_barrier
  ds_read_b128 v[80:83], v4 offset:16384
  v_mfma_f32_32x32x16_bf16 v[32:47], v[84:87], a[56:59], v[32:47]
  ds_read_b128 v[84:87], v4 offset:49152
  v_mfma_f32_32x32x16_bf16 v[48:63], v[88:91], a[56:59], v[48:63]
  ds_read_b128 v[88:91], v13 offset:16384
  v_mfma_f32_32x32x16_bf16 v[64:79], v[92:95], a[56:59], v[64:79]
  ds_read_b128 v[92:95], v13 offset:49152
  s_waitcnt lgkmcnt(4)
  v_mfma_f32_32x32x16_bf16 v[16:31], v[96:99], a[60:63], v[16:31]
  ds_read_b128 v[96:99], v4 offset:17408
  v_mfma_f32_32x32x16_bf16 v[32:47], v[100:103], a[60:63], v[32:47]
  ds_read_b128 v[100:103], v4 offset:50176
  v_mfma_f32_32x32x16_bf16 v[48:63], v[104:107], a[60:63], v[48:63]
  ds_read_b128 v[104:107], v13 offset:17408
  v_mfma_f32_32x32x16_bf16 v[64:79], v[108:111], a[60:63], v[64:79]
  ds_read_b128 v[108:111], v13 offset:50176
  s_waitcnt vmcnt(31)
  s_waitcnt vmcnt(20)
  s_waitcnt lgkmcnt(4)
  v_mfma_f32_32x32x16_bf16 v[16:31], v[80:83], a[64:67], v[16:31]
  ds_read_b128 v[80:83], v4 offset:18432
  v_add_f32 v8, v128, v130
  v_add_f32 v9, v129, v131
  v_add_f32 v8, v8, v132
  v_mfma_f32_32x32x16_bf16 v[32:47], v[84:87], a[64:67], v[32:47]
  ds_read_b128 v[84:87], v4 offset:51200
  v_add_f32 v9, v9, v133
  v_add_f32 v8, v8, v134
  v_add_f32 v9, v9, v135
  v_mfma_f32_32x32x16_bf16 v[48:63], v[88:91], a[64:67], v[48:63]
  ds_read_b128 v[88:91], v13 offset:18432
  v_add_f32 v8, v8, v136
  v_add_f32 v9, v9, v137
  v_add_f32 v8, v8, v138
  v_mfma_f32_32x32x16_bf16 v[64:79], v[92:95], a[64:67], v[64:79]
  ds_read_b128 v[92:95], v13 offset:51200
  v_add_f32 v9, v9, v139
  v_add_f32 v8, v8, v140
  v_add_f32 v9, v9, v141
  s_waitcnt lgkmcnt(4)
  v_mfma_f32_32x32x16_bf16 v[16:31], v[96:99], a[68:71], v[16:31]
  ds_read_b128 v[96:99], v4 offset:19456
  v_add_f32 v8, v8, v142
  v_add_f32 v9, v9, v143
  v_mov_b32 v10, v8
  v_mfma_f32_32x32x16_bf16 v[32:47], v[100:103], a[68:71], v[32:47]
  ds_read_b128 v[100:103], v4 offset:52224
  v_mov_b32 v11, v9
  s_nop 1
  v_permlane32_swap_b32 v8, v10
  v_mfma_f32_32x32x16_bf16 v[48:63], v[104:107], a[68:71], v[48:63]
  ds_read_b128 v[104:107], v13 offset:19456
  v_permlane32_swap_b32 v9, v11
  s_nop 1
  v_add_f32 v8, v8, v10
  v_mfma_f32_32x32x16_bf16 v[64:79], v[108:111], a[68:71], v[64:79]
  ds_read_b128 v[108:111], v13 offset:52224
  v_add_f32 v9, v9, v11
  v_mul_f32 v8, 0x3b000000, v8
  v_mul_f32 v9, 0x3b000000, v9
  s_waitcnt lgkmcnt(4)
  v_mfma_f32_32x32x16_bf16 v[16:31], v[80:83], a[72:75], v[16:31]
  ds_read_b128 v[80:83], v4 offset:20480
  v_fma_f32 v9, -v8, v8, v9
  v_max_f32 v9, 0, v9
  v_add_f32 v9, 0x3727c5ac, v9
  v_mfma_f32_32x32x16_bf16 v[32:47], v[84:87], a[72:75], v[32:47]
  ds_read_b128 v[84:87], v4 offset:53248
  v_rsq_f32 v9, v9
  v_cvt_pk_bf16_f32 v144, v8, v8
  v_and_b32 v10, 0xffff0000, v144
  v_mfma_f32_32x32x16_bf16 v[48:63], v[88:91], a[72:75], v[48:63]
  ds_read_b128 v[88:91], v13 offset:20480
  v_sub_f32 v10, v8, v10
  v_cvt_pk_bf16_f32 v145, v10, v10
  v_cmp_eq_u32 vcc, 0, v3
  v_mfma_f32_32x32x16_bf16 v[64:79], v[92:95], a[72:75], v[64:79]
  ds_read_b128 v[92:95], v13 offset:53248
  v_mov_b32 v146, 0
  v_mov_b32 v147, 0
  v_cndmask_b32 v144, 0, v144, vcc
  s_waitcnt lgkmcnt(4)
  v_mfma_f32_32x32x16_bf16 v[16:31], v[96:99], a[76:79], v[16:31]
  ds_read_b128 v[96:99], v4 offset:21504
  v_cndmask_b32 v145, 0, v145, vcc
  v_mul_f32 v12, 0xbfb8aa3b, v9
  v_mov_b32 v14, 0xbfb8aa3b
  v_mfma_f32_32x32x16_bf16 v[32:47], v[100:103], a[76:79], v[32:47]
  ds_read_b128 v[100:103], v4 offset:54272
  v_mov_b32 v15, 0xbfb8aa3b
  v_mfma_f32_32x32x16_bf16 v[48:63], v[104:107], a[76:79], v[48:63]
  ds_read_b128 v[104:107], v13 offset:21504
  v_mfma_f32_32x32x16_bf16 v[64:79], v[108:111], a[76:79], v[64:79]
  ds_read_b128 v[108:111], v13 offset:54272
  s_waitcnt lgkmcnt(4)
  v_mfma_f32_32x32x16_bf16 v[16:31], v[80:83], a[80:83], v[16:31]
  ds_read_b128 v[80:83], v4 offset:22528
  v_mfma_f32_32x32x16_bf16 v[32:47], v[84:87], a[80:83], v[32:47]
  ds_read_b128 v[84:87], v4 offset:55296
  v_mfma_f32_32x32x16_bf16 v[48:63], v[88:91], a[80:83], v[48:63]
  ds_read_b128 v[88:91], v13 offset:22528
  v_mfma_f32_32x32x16_bf16 v[64:79], v[92:95], a[80:83], v[64:79]
  ds_read_b128 v[92:95], v13 offset:55296
  s_waitcnt lgkmcnt(4)
  v_mfma_f32_32x32x16_bf16 v[16:31], v[96:99], a[84:87], v[16:31]
  ds_read_b128 v[96:99], v4 offset:23552
  v_mfma_f32_32x32x16_bf16 v[32:47], v[100:103], a[84:87], v[32:47]
  ds_read_b128 v[100:103], v4 offset:56320
  v_mfma_f32_32x32x16_bf16 v[48:63], v[104:107], a[84:87], v[48:63]
  ds_read_b128 v[104:107], v13 offset:23552
  v_mfma_f32_32x32x16_bf16 v[64:79], v[108:111], a[84:87], v[64:79]
  ds_read_b128 v[108:111], v13 offset:56320
  s_waitcnt lgkmcnt(4)
  v_mfma_f32_32x32x16_bf16 v[16:31], v[80:83], a[88:91], v[16:31]
  s_waitcnt vmcnt(12)
  s_barrier
  ds_read_b128 v[80:83], v4 offset:24576
  v_mfma_f32_32x32x16_bf16 v[32:47], v[84:87], a[88:91], v[32:47]
  ds_read_b128 v[84:87], v4 offset:57344
  v_mfma_f32_32x32x16_bf16 v[48:63], v[88:91], a[88:91], v[48:63]
  ds_read_b128 v[88:91], v13 offset:24576
  v_mfma_f32_32x32x16_bf16 v[64:79], v[92:95], a[88:91], v[64:79]
  ds_read_b128 v[92:95], v13 offset:57344
  s_waitcnt lgkmcnt(4)
  v_mfma_f32_32x32x16_bf16 v[16:31], v[96:99], a[92:95], v[16:31]
  ds_read_b128 v[96:99], v4 offset:25600
  v_mfma_f32_32x32x16_bf16 v[32:47], v[100:103], a[92:95], v[32:47]
  ds_read_b128 v[100:103], v4 offset:58368
  v_mfma_f32_32x32x16_bf16 v[48:63], v[104:107], a[92:95], v[48:63]
  ds_read_b128 v[104:107], v13 offset:25600
  v_mfma_f32_32x32x16_bf16 v[64:79], v[108:111], a[92:95], v[64:79]
  ds_read_b128 v[108:111], v13 offset:58368
  s_waitcnt vmcnt(11)
  s_waitcnt lgkmcnt(4)
  v_mfma_f32_32x32x16_bf16 v[16:31], v[80:83], a[96:99], v[16:31]
  ds_read_b128 v[80:83], v4 offset:26624
  v_mfma_f32_32x32x16_bf16 v[32:47], v[84:87], a[96:99], v[32:47]
  ds_read_b128 v[84:87], v4 offset:59392
  v_mfma_f32_32x32x16_bf16 v[48:63], v[88:91], a[96:99], v[48:63]
  ds_read_b128 v[88:91], v13 offset:26624
  v_mfma_f32_32x32x16_bf16 v[64:79], v[92:95], a[96:99], v[64:79]
  ds_read_b128 v[92:95], v13 offset:59392
  s_waitcnt vmcnt(10)
  s_waitcnt lgkmcnt(4)
  v_mfma_f32_32x32x16_bf16 v[16:31], v[96:99], a[100:103], v[16:31]
  ds_read_b128 v[96:99], v4 offset:27648
  v_mfma_f32_32x32x16_bf16 v[32:47], v[100:103], a[100:103], v[32:47]
  ds_read_b128 v[100:103], v4 offset:60416
  v_mfma_f32_32x32x16_bf16 v[48:63], v[104:107], a[100:103], v[48:63]
  ds_read_b128 v[104:107], v13 offset:27648
  v_mfma_f32_32x32x16_bf16 v[64:79], v[108:111], a[100:103], v[64:79]
  ds_read_b128 v[108:111], v13 offset:60416
  s_waitcnt vmcnt(9)
  s_waitcnt lgkmcnt(4)
  v_mfma_f32_32x32x16_bf16 v[16:31], v[80:83], a[104:107], v[16:31]
  ds_read_b128 v[80:83], v4 offset:28672
  v_mfma_f32_32x32x16_bf16 v[32:47], v[84:87], a[104:107], v[32:47]
  ds_read_b128 v[84:87], v4 offset:61440
  v_mfma_f32_32x32x16_bf16 v[48:63], v[88:91], a[104:107], v[48:63]
  ds_read_b128 v[88:91], v13 offset:28672
  v_mfma_f32_32x32x16_bf16 v[64:79], v[92:95], a[104:107], v[64:79]
  ds_read_b128 v[92:95], v13 offset:61440
  s_waitcnt vmcnt(8)
  s_waitcnt lgkmcnt(4)
  v_mfma_f32_32x32x16_bf16 v[16:31], v[96:99], a[108:111], v[16:31]
  ds_read_b128 v[96:99], v4 offset:29696
  v_mfma_f32_32x32x16_bf16 v[32:47], v[100:103], a[108:111], v[32:47]
  ds_read_b128 v[100:103], v4 offset:62464
  v_mfma_f32_32x32x16_bf16 v[48:63], v[104:107], a[108:111], v[48:63]
  ds_read_b128 v[104:107], v13 offset:29696
  v_mfma_f32_32x32x16_bf16 v[64:79], v[108:111], a[108:111], v[64:79]
  ds_read_b128 v[108:111], v13 offset:62464
  s_waitcnt vmcnt(7)
  s_waitcnt lgkmcnt(4)
  v_mfma_f32_32x32x16_bf16 v[16:31], v[80:83], a[112:115], v[16:31]
  ds_read_b128 v[80:83], v4 offset:30720
  v_mfma_f32_32x32x16_bf16 v[32:47], v[84:87], a[112:115], v[32:47]
  ds_read_b128 v[84:87], v4 offset:63488
  v_mfma_f32_32x32x16_bf16 v[48:63], v[88:91], a[112:115], v[48:63]
  ds_read_b128 v[88:91], v13 offset:30720
  v_mfma_f32_32x32x16_bf16 v[64:79], v[92:95], a[112:115], v[64:79]
  ds_read_b128 v[92:95], v13 offset:63488
  s_waitcnt vmcnt(6)
  s_waitcnt lgkmcnt(4)
  v_mfma_f32_32x32x16_bf16 v[16:31], v[96:99], a[116:119], v[16:31]
  ds_read_b128 v[96:99], v4 offset:31744
  v_mfma_f32_32x32x16_bf16 v[32:47], v[100:103], a[116:119], v[32:47]
  ds_read_b128 v[100:103], v4 offset:64512
  v_mfma_f32_32x32x16_bf16 v[48:63], v[104:107], a[116:119], v[48:63]
  ds_read_b128 v[104:107], v13 offset:31744
  v_mfma_f32_32x32x16_bf16 v[64:79], v[108:111], a[116:119], v[64:79]
  ds_read_b128 v[108:111], v13 offset:64512
  s_waitcnt vmcnt(5)
  s_waitcnt lgkmcnt(4)
  v_mfma_f32_32x32x16_bf16 v[16:31], v[80:83], a[120:123], v[16:31]
  v_mfma_f32_32x32x16_bf16 v[32:47], v[84:87], a[120:123], v[32:47]
  v_mfma_f32_32x32x16_bf16 v[48:63], v[88:91], a[120:123], v[48:63]
  v_mfma_f32_32x32x16_bf16 v[64:79], v[92:95], a[120:123], v[64:79]
  s_waitcnt vmcnt(4)
  s_waitcnt lgkmcnt(0)
  v_mfma_f32_32x32x16_bf16 v[16:31], v[96:99], a[124:127], v[16:31]
  v_mfma_f32_32x32x16_bf16 v[32:47], v[100:103], a[124:127], v[32:47]
  v_mfma_f32_32x32x16_bf16 v[48:63], v[104:107], a[124:127], v[48:63]
  v_mfma_f32_32x32x16_bf16 v[64:79], v[108:111], a[124:127], v[64:79]
  s_waitcnt vmcnt(0)
  v_mfma_f32_32x32x16_bf16 v[16:31], v[112:115], v[144:147], v[16:31]
  v_mfma_f32_32x32x16_bf16 v[32:47], v[116:119], v[144:147], v[32:47]
  v_mfma_f32_32x32x16_bf16 v[48:63], v[120:123], v[144:147], v[48:63]
  v_mfma_f32_32x32x16_bf16 v[64:79], v[124:127], v[144:147], v[64:79]
  s_nop 13
  v_pk_mul_f32 v[16:17], v[12:13], v[16:17] op_sel_hi:[0,1]
  v_pk_mul_f32 v[18:19], v[12:13], v[18:19] op_sel_hi:[0,1]
  v_exp_f32 v156, v16
  v_exp_f32 v157, v17
  v_exp_f32 v158, v18
  v_exp_f32 v159, v19
  s_nop 0
  v_pk_fma_f32 v[156:157], v[156:157], v[14:15], v[14:15]
  v_pk_fma_f32 v[158:159], v[158:159], v[14:15], v[14:15]
  v_rcp_f32 v156, v156
  v_rcp_f32 v157, v157
  v_rcp_f32 v158, v158
  v_rcp_f32 v159, v159
  s_nop 0
  v_pk_mul_f32 v[16:17], v[156:157], v[16:17]
  v_pk_mul_f32 v[18:19], v[158:159], v[18:19]
  v_cvt_pk_bf16_f32 v148, v16, v17
  v_cvt_pk_bf16_f32 v149, v18, v19
  v_pk_mul_f32 v[20:21], v[12:13], v[20:21] op_sel_hi:[0,1]
  v_pk_mul_f32 v[22:23], v[12:13], v[22:23] op_sel_hi:[0,1]
  v_exp_f32 v156, v20
  v_exp_f32 v157, v21
  v_exp_f32 v158, v22
  v_exp_f32 v159, v23
  s_nop 0
  v_pk_fma_f32 v[156:157], v[156:157], v[14:15], v[14:15]
  v_pk_fma_f32 v[158:159], v[158:159], v[14:15], v[14:15]
  v_rcp_f32 v156, v156
  v_rcp_f32 v157, v157
  v_rcp_f32 v158, v158
  v_rcp_f32 v159, v159
  s_nop 0
  v_pk_mul_f32 v[20:21], v[156:157], v[20:21]
  v_pk_mul_f32 v[22:23], v[158:159], v[22:23]
  v_cvt_pk_bf16_f32 v150, v20, v21
  v_cvt_pk_bf16_f32 v151, v22, v23
  v_pk_mul_f32 v[24:25], v[12:13], v[24:25] op_sel_hi:[0,1]
  v_pk_mul_f32 v[26:27], v[12:13], v[26:27] op_sel_hi:[0,1]
  v_exp_f32 v156, v24
  v_exp_f32 v157, v25
  v_exp_f32 v158, v26
  v_exp_f32 v159, v27
  s_nop 0
  v_pk_fma_f32 v[156:157], v[156:157], v[14:15], v[14:15]
  v_pk_fma_f32 v[158:159], v[158:159], v[14:15], v[14:15]
  v_rcp_f32 v156, v156
  v_rcp_f32 v157, v157
  v_rcp_f32 v158, v158
  v_rcp_f32 v159, v159
  s_nop 0
  v_pk_mul_f32 v[24:25], v[156:157], v[24:25]
  v_pk_mul_f32 v[26:27], v[158:159], v[26:27]
  v_cvt_pk_bf16_f32 v152, v24, v25
  v_cvt_pk_bf16_f32 v153, v26, v27
  v_pk_mul_f32 v[28:29], v[12:13], v[28:29] op_sel_hi:[0,1]
  v_pk_mul_f32 v[30:31], v[12:13], v[30:31] op_sel_hi:[0,1]
  v_exp_f32 v156, v28
  v_exp_f32 v157, v29
  v_exp_f32 v158, v30
  v_exp_f32 v159, v31
  s_nop 0
  v_pk_fma_f32 v[156:157], v[156:157], v[14:15], v[14:15]
  v_pk_fma_f32 v[158:159], v[158:159], v[14:15], v[14:15]
  v_rcp_f32 v156, v156
  v_rcp_f32 v157, v157
  v_rcp_f32 v158, v158
  v_rcp_f32 v159, v159
  s_nop 0
  v_pk_mul_f32 v[28:29], v[156:157], v[28:29]
  v_pk_mul_f32 v[30:31], v[158:159], v[30:31]
  v_cvt_pk_bf16_f32 v154, v28, v29
  v_cvt_pk_bf16_f32 v155, v30, v31
  buffer_store_dwordx4 v[148:151], v4, s[24:27], s40 offen offset:0 sc1
  buffer_store_dwordx4 v[152:155], v4, s[24:27], s40 offen offset:1024 sc1
  v_pk_mul_f32 v[32:33], v[12:13], v[32:33] op_sel_hi:[0,1]
  v_pk_mul_f32 v[34:35], v[12:13], v[34:35] op_sel_hi:[0,1]
  v_exp_f32 v156, v32
  v_exp_f32 v157, v33
  v_exp_f32 v158, v34
  v_exp_f32 v159, v35
  s_nop 0
  v_pk_fma_f32 v[156:157], v[156:157], v[14:15], v[14:15]
  v_pk_fma_f32 v[158:159], v[158:159], v[14:15], v[14:15]
  v_rcp_f32 v156, v156
  v_rcp_f32 v157, v157
  v_rcp_f32 v158, v158
  v_rcp_f32 v159, v159
  s_nop 0
  v_pk_mul_f32 v[32:33], v[156:157], v[32:33]
  v_pk_mul_f32 v[34:35], v[158:159], v[34:35]
  v_cvt_pk_bf16_f32 v148, v32, v33
  v_cvt_pk_bf16_f32 v149, v34, v35
  v_pk_mul_f32 v[36:37], v[12:13], v[36:37] op_sel_hi:[0,1]
  v_pk_mul_f32 v[38:39], v[12:13], v[38:39] op_sel_hi:[0,1]
  v_exp_f32 v156, v36
  v_exp_f32 v157, v37
  v_exp_f32 v158, v38
  v_exp_f32 v159, v39
  s_nop 0
  v_pk_fma_f32 v[156:157], v[156:157], v[14:15], v[14:15]
  v_pk_fma_f32 v[158:159], v[158:159], v[14:15], v[14:15]
  v_rcp_f32 v156, v156
  v_rcp_f32 v157, v157
  v_rcp_f32 v158, v158
  v_rcp_f32 v159, v159
  s_nop 0
  v_pk_mul_f32 v[36:37], v[156:157], v[36:37]
  v_pk_mul_f32 v[38:39], v[158:159], v[38:39]
  v_cvt_pk_bf16_f32 v150, v36, v37
  v_cvt_pk_bf16_f32 v151, v38, v39
  v_pk_mul_f32 v[40:41], v[12:13], v[40:41] op_sel_hi:[0,1]
  v_pk_mul_f32 v[42:43], v[12:13], v[42:43] op_sel_hi:[0,1]
  v_exp_f32 v156, v40
  v_exp_f32 v157, v41
  v_exp_f32 v158, v42
  v_exp_f32 v159, v43
  s_nop 0
  v_pk_fma_f32 v[156:157], v[156:157], v[14:15], v[14:15]
  v_pk_fma_f32 v[158:159], v[158:159], v[14:15], v[14:15]
  v_rcp_f32 v156, v156
  v_rcp_f32 v157, v157
  v_rcp_f32 v158, v158
  v_rcp_f32 v159, v159
  s_nop 0
  v_pk_mul_f32 v[40:41], v[156:157], v[40:41]
  v_pk_mul_f32 v[42:43], v[158:159], v[42:43]
  v_cvt_pk_bf16_f32 v152, v40, v41
  v_cvt_pk_bf16_f32 v153, v42, v43
  v_pk_mul_f32 v[44:45], v[12:13], v[44:45] op_sel_hi:[0,1]
  v_pk_mul_f32 v[46:47], v[12:13], v[46:47] op_sel_hi:[0,1]
  v_exp_f32 v156, v44
  v_exp_f32 v157, v45
  v_exp_f32 v158, v46
  v_exp_f32 v159, v47
  s_nop 0
  v_pk_fma_f32 v[156:157], v[156:157], v[14:15], v[14:15]
  v_pk_fma_f32 v[158:159], v[158:159], v[14:15], v[14:15]
  v_rcp_f32 v156, v156
  v_rcp_f32 v157, v157
  v_rcp_f32 v158, v158
  v_rcp_f32 v159, v159
  s_nop 0
  v_pk_mul_f32 v[44:45], v[156:157], v[44:45]
  v_pk_mul_f32 v[46:47], v[158:159], v[46:47]
  v_cvt_pk_bf16_f32 v154, v44, v45
  v_cvt_pk_bf16_f32 v155, v46, v47
  buffer_store_dwordx4 v[148:151], v4, s[24:27], s40 offen offset:2048 sc1
  buffer_store_dwordx4 v[152:155], v4, s[24:27], s40 offen offset:3072 sc1
  s_add_u32 s40, s40, 4096
  v_pk_mul_f32 v[48:49], v[12:13], v[48:49] op_sel_hi:[0,1]
  v_pk_mul_f32 v[50:51], v[12:13], v[50:51] op_sel_hi:[0,1]
  v_exp_f32 v156, v48
  v_exp_f32 v157, v49
  v_exp_f32 v158, v50
  v_exp_f32 v159, v51
  s_nop 0
  v_pk_fma_f32 v[156:157], v[156:157], v[14:15], v[14:15]
  v_pk_fma_f32 v[158:159], v[158:159], v[14:15], v[14:15]
  v_rcp_f32 v156, v156
  v_rcp_f32 v157, v157
  v_rcp_f32 v158, v158
  v_rcp_f32 v159, v159
  s_nop 0
  v_pk_mul_f32 v[48:49], v[156:157], v[48:49]
  v_pk_mul_f32 v[50:51], v[158:159], v[50:51]
  v_cvt_pk_bf16_f32 v148, v48, v49
  v_cvt_pk_bf16_f32 v149, v50, v51
  v_pk_mul_f32 v[52:53], v[12:13], v[52:53] op_sel_hi:[0,1]
  v_pk_mul_f32 v[54:55], v[12:13], v[54:55] op_sel_hi:[0,1]
  v_exp_f32 v156, v52
  v_exp_f32 v157, v53
  v_exp_f32 v158, v54
  v_exp_f32 v159, v55
  s_nop 0
  v_pk_fma_f32 v[156:157], v[156:157], v[14:15], v[14:15]
  v_pk_fma_f32 v[158:159], v[158:159], v[14:15], v[14:15]
  v_rcp_f32 v156, v156
  v_rcp_f32 v157, v157
  v_rcp_f32 v158, v158
  v_rcp_f32 v159, v159
  s_nop 0
  v_pk_mul_f32 v[52:53], v[156:157], v[52:53]
  v_pk_mul_f32 v[54:55], v[158:159], v[54:55]
  v_cvt_pk_bf16_f32 v150, v52, v53
  v_cvt_pk_bf16_f32 v151, v54, v55
  v_pk_mul_f32 v[56:57], v[12:13], v[56:57] op_sel_hi:[0,1]
  v_pk_mul_f32 v[58:59], v[12:13], v[58:59] op_sel_hi:[0,1]
  v_exp_f32 v156, v56
  v_exp_f32 v157, v57
  v_exp_f32 v158, v58
  v_exp_f32 v159, v59
  s_nop 0
  v_pk_fma_f32 v[156:157], v[156:157], v[14:15], v[14:15]
  v_pk_fma_f32 v[158:159], v[158:159], v[14:15], v[14:15]
  v_rcp_f32 v156, v156
  v_rcp_f32 v157, v157
  v_rcp_f32 v158, v158
  v_rcp_f32 v159, v159
  s_nop 0
  v_pk_mul_f32 v[56:57], v[156:157], v[56:57]
  v_pk_mul_f32 v[58:59], v[158:159], v[58:59]
  v_cvt_pk_bf16_f32 v152, v56, v57
  v_cvt_pk_bf16_f32 v153, v58, v59
  v_pk_mul_f32 v[60:61], v[12:13], v[60:61] op_sel_hi:[0,1]
  v_pk_mul_f32 v[62:63], v[12:13], v[62:63] op_sel_hi:[0,1]
  v_exp_f32 v156, v60
  v_exp_f32 v157, v61
  v_exp_f32 v158, v62
  v_exp_f32 v159, v63
  s_nop 0
  v_pk_fma_f32 v[156:157], v[156:157], v[14:15], v[14:15]
  v_pk_fma_f32 v[158:159], v[158:159], v[14:15], v[14:15]
  v_rcp_f32 v156, v156
  v_rcp_f32 v157, v157
  v_rcp_f32 v158, v158
  v_rcp_f32 v159, v159
  s_nop 0
  v_pk_mul_f32 v[60:61], v[156:157], v[60:61]
  v_pk_mul_f32 v[62:63], v[158:159], v[62:63]
  v_cvt_pk_bf16_f32 v154, v60, v61
  v_cvt_pk_bf16_f32 v155, v62, v63
  buffer_store_dwordx4 v[148:151], v4, s[24:27], s40 offen offset:0 sc1
  buffer_store_dwordx4 v[152:155], v4, s[24:27], s40 offen offset:1024 sc1
  v_pk_mul_f32 v[64:65], v[12:13], v[64:65] op_sel_hi:[0,1]
  v_pk_mul_f32 v[66:67], v[12:13], v[66:67] op_sel_hi:[0,1]
  v_exp_f32 v156, v64
  v_exp_f32 v157, v65
  v_exp_f32 v158, v66
  v_exp_f32 v159, v67
  s_nop 0
  v_pk_fma_f32 v[156:157], v[156:157], v[14:15], v[14:15]
  v_pk_fma_f32 v[158:159], v[158:159], v[14:15], v[14:15]
  v_rcp_f32 v156, v156
  v_rcp_f32 v157, v157
  v_rcp_f32 v158, v158
  v_rcp_f32 v159, v159
  s_nop 0
  v_pk_mul_f32 v[64:65], v[156:157], v[64:65]
  v_pk_mul_f32 v[66:67], v[158:159], v[66:67]
  v_cvt_pk_bf16_f32 v148, v64, v65
  v_cvt_pk_bf16_f32 v149, v66, v67
  v_pk_mul_f32 v[68:69], v[12:13], v[68:69] op_sel_hi:[0,1]
  v_pk_mul_f32 v[70:71], v[12:13], v[70:71] op_sel_hi:[0,1]
  v_exp_f32 v156, v68
  v_exp_f32 v157, v69
  v_exp_f32 v158, v70
  v_exp_f32 v159, v71
  s_nop 0
  v_pk_fma_f32 v[156:157], v[156:157], v[14:15], v[14:15]
  v_pk_fma_f32 v[158:159], v[158:159], v[14:15], v[14:15]
  v_rcp_f32 v156, v156
  v_rcp_f32 v157, v157
  v_rcp_f32 v158, v158
  v_rcp_f32 v159, v159
  s_nop 0
  v_pk_mul_f32 v[68:69], v[156:157], v[68:69]
  v_pk_mul_f32 v[70:71], v[158:159], v[70:71]
  v_cvt_pk_bf16_f32 v150, v68, v69
  v_cvt_pk_bf16_f32 v151, v70, v71
  v_pk_mul_f32 v[72:73], v[12:13], v[72:73] op_sel_hi:[0,1]
  v_pk_mul_f32 v[74:75], v[12:13], v[74:75] op_sel_hi:[0,1]
  v_exp_f32 v156, v72
  v_exp_f32 v157, v73
  v_exp_f32 v158, v74
  v_exp_f32 v159, v75
  s_nop 0
  v_pk_fma_f32 v[156:157], v[156:157], v[14:15], v[14:15]
  v_pk_fma_f32 v[158:159], v[158:159], v[14:15], v[14:15]
  v_rcp_f32 v156, v156
  v_rcp_f32 v157, v157
  v_rcp_f32 v158, v158
  v_rcp_f32 v159, v159
  s_nop 0
  v_pk_mul_f32 v[72:73], v[156:157], v[72:73]
  v_pk_mul_f32 v[74:75], v[158:159], v[74:75]
  v_cvt_pk_bf16_f32 v152, v72, v73
  v_cvt_pk_bf16_f32 v153, v74, v75
  v_pk_mul_f32 v[76:77], v[12:13], v[76:77] op_sel_hi:[0,1]
  v_pk_mul_f32 v[78:79], v[12:13], v[78:79] op_sel_hi:[0,1]
  v_exp_f32 v156, v76
  v_exp_f32 v157, v77
  v_exp_f32 v158, v78
  v_exp_f32 v159, v79
  s_nop 0
  v_pk_fma_f32 v[156:157], v[156:157], v[14:15], v[14:15]
  v_pk_fma_f32 v[158:159], v[158:159], v[14:15], v[14:15]
  v_rcp_f32 v156, v156
  v_rcp_f32 v157, v157
  v_rcp_f32 v158, v158
  v_rcp_f32 v159, v159
  s_nop 0
  v_pk_mul_f32 v[76:77], v[156:157], v[76:77]
  v_pk_mul_f32 v[78:79], v[158:159], v[78:79]
  v_cvt_pk_bf16_f32 v154, v76, v77
  v_cvt_pk_bf16_f32 v155, v78, v79
  buffer_store_dwordx4 v[148:151], v4, s[24:27], s40 offen offset:2048 sc1
  buffer_store_dwordx4 v[152:155], v4, s[24:27], s40 offen offset:3072 sc1
ffn1_kernel_exit:
  s_endpgm
ffn1_kernel_pfx:
  s_cmp_ge_u32 s2, 256
  s_cbranch_scc1 ffn1_kernel_exit2
  s_load_dwordx2 s[4:5], s[0:1], 64
  v_lshrrev_b32 v1, 6, v0
  v_and_b32 v0, 63, v0
  s_nop 0
  v_readfirstlane_b32 s3, v1
  s_waitcnt lgkmcnt(0)

  s_add_u32 s52, s4, 0x3e0000
  s_addc_u32 s53, s5, 0
  s_mov_b32 s54, 0x1c0000
  s_mov_b32 s55, 0x20000
  s_lshr_b32 s47, s2, 3
  s_sub_u32 s47, s47, 28
  s_mul_i32 s47, s47, 4
  s_add_u32 s47, s47, s3
  s_mul_i32 s47, s47, 8192
  v_mul_u32_u24 v14, 128, v0
  v_add_u32 v14, s47, v14
  s_mov_b32 s47, 0x0
  buffer_load_dword v16, v14, s[52:55], s47 offen
  s_mov_b32 s47, 0x20000
  buffer_load_dword v16, v14, s[52:55], s47 offen
  s_mov_b32 s47, 0x40000
  buffer_load_dword v16, v14, s[52:55], s47 offen
  s_mov_b32 s47, 0x60000
  buffer_load_dword v16, v14, s[52:55], s47 offen
  s_mov_b32 s47, 0x80000
  buffer_load_dword v16, v14, s[52:55], s47 offen
  s_mov_b32 s47, 0xa0000
  buffer_load_dword v16, v14, s[52:55], s47 offen
  s_mov_b32 s47, 0xc0000
  buffer_load_dword v16, v14, s[52:55], s47 offen
  s_mov_b32 s47, 0xe0000
  buffer_load_dword v16, v14, s[52:55], s47 offen
  s_mov_b32 s47, 0x100000
  buffer_load_dword v16, v14, s[52:55], s47 offen
  s_mov_b32 s47, 0x120000
  buffer_load_dword v16, v14, s[52:55], s47 offen
  s_mov_b32 s47, 0x140000
  buffer_load_dword v16, v14, s[52:55], s47 offen
  s_mov_b32 s47, 0x160000
  buffer_load_dword v16, v14, s[52:55], s47 offen
  s_mov_b32 s47, 0x180000
  buffer_load_dword v16, v14, s[52:55], s47 offen
  s_mov_b32 s47, 0x1a0000
  buffer_load_dword v16, v14, s[52:55], s47 offen
  s_waitcnt vmcnt(0)
ffn1_kernel_exit2:
  s_endpgm
.text
.globl ffn2_kernel
.p2align 8
.type ffn2_kernel,@function
ffn2_kernel:
  s_cmp_ge_u32 s2, 256
  s_cbranch_scc1 ffn2_kernel_exit
  s_load_dwordx2 s[4:5], s[0:1], 64
  s_load_dwordx2 s[6:7], s[0:1], 48
  v_lshrrev_b32 v1, 6, v0
  v_and_b32 v0, 63, v0
  s_and_b32 s28, s2, 7
  v_readfirstlane_b32 s3, v1
  s_lshl_b32 s28, s28, 2
  s_bfe_u32 s29, s2, 0x20003
  s_add_u32 s28, s28, s29
  s_lshr_b32 s29, s2, 5
  v_lshlrev_b32 v4, 4, v0
  s_lshr_b32 s30, s3, 1
  s_and_b32 s31, s3, 1
  s_lshl_b32 s32, s29, 1
  s_add_u32 s33, s32, s30
  s_xor_b32 s34, s33, 1
  s_lshl_b32 s32, s28, 1
  s_add_u32 s35, s32, s31
  s_xor_b32 s36, s35, 1
  s_mul_i32 s37, s3, 28672
  s_mul_i32 s40, s33, 114688
  s_mul_i32 s41, s34, 114688
  s_mul_i32 s42, s35, 114688
  s_mul_i32 s43, s36, 114688
  s_add_u32 s40, s40, s37
  s_add_u32 s41, s41, s37
  s_add_u32 s42, s42, s37
  s_add_u32 s43, s43, s37
  s_waitcnt lgkmcnt(0)

  s_add_u32 s8, s4, 0x1280000
  s_addc_u32 s9, s5, 0
  s_mov_b32 s10, 0x700000
  s_mov_b32 s11, 0x20000
  s_add_u32 s12, s4, 0x3e0000
  s_addc_u32 s13, s5, 0
  s_mov_b32 s14, 0x1c0000
  s_mov_b32 s15, 0x20000
  buffer_load_dwordx4 a[0:3], v4, s[12:15], s40 offen offset:0
  buffer_load_dwordx4 a[8:11], v4, s[8:11], s42 offen offset:0
  buffer_load_dwordx4 a[4:7], v4, s[12:15], s41 offen offset:0
  buffer_load_dwordx4 a[12:15], v4, s[8:11], s43 offen offset:0
  buffer_load_dwordx4 a[16:19], v4, s[12:15], s40 offen offset:1024
  buffer_load_dwordx4 a[24:27], v4, s[8:11], s42 offen offset:1024
  buffer_load_dwordx4 a[20:23], v4, s[12:15], s41 offen offset:1024
  buffer_load_dwordx4 a[28:31], v4, s[8:11], s43 offen offset:1024
  buffer_load_dwordx4 a[32:35], v4, s[12:15], s40 offen offset:2048
  buffer_load_dwordx4 a[40:43], v4, s[8:11], s42 offen offset:2048
  buffer_load_dwordx4 a[36:39], v4, s[12:15], s41 offen offset:2048
  buffer_load_dwordx4 a[44:47], v4, s[8:11], s43 offen offset:2048
  buffer_load_dwordx4 a[48:51], v4, s[12:15], s40 offen offset:3072
  buffer_load_dwordx4 a[56:59], v4, s[8:11], s42 offen offset:3072
  buffer_load_dwordx4 a[52:55], v4, s[12:15], s41 offen offset:3072
  buffer_load_dwordx4 a[60:63], v4, s[8:11], s43 offen offset:3072
  s_add_u32 s40, s40, 4096
  s_add_u32 s41, s41, 4096
  s_add_u32 s42, s42, 4096
  s_add_u32 s43, s43, 4096
  buffer_load_dwordx4 a[64:67], v4, s[12:15], s40 offen offset:0
  buffer_load_dwordx4 a[72:75], v4, s[8:11], s42 offen offset:0
  buffer_load_dwordx4 a[68:71], v4, s[12:15], s41 offen offset:0
  buffer_load_dwordx4 a[76:79], v4, s[8:11], s43 offen offset:0
  buffer_load_dwordx4 a[80:83], v4, s[12:15], s40 offen offset:1024
  buffer_load_dwordx4 a[88:91], v4, s[8:11], s42 offen offset:1024
  buffer_load_dwordx4 a[84:87], v4, s[12:15], s41 offen offset:1024
  buffer_load_dwordx4 a[92:95], v4, s[8:11], s43 offen offset:1024
  buffer_load_dwordx4 a[96:99], v4, s[12:15], s40 offen offset:2048
  buffer_load_dwordx4 a[104:107], v4, s[8:11], s42 offen offset:2048
  buffer_load_dwordx4 a[100:103], v4, s[12:15], s41 offen offset:2048
  buffer_load_dwordx4 a[108:111], v4, s[8:11], s43 offen offset:2048
  buffer_load_dwordx4 a[112:115], v4, s[12:15], s40 offen offset:3072
  buffer_load_dwordx4 a[120:123], v4, s[8:11], s42 offen offset:3072
  buffer_load_dwordx4 a[116:119], v4, s[12:15], s41 offen offset:3072
  buffer_load_dwordx4 a[124:127], v4, s[8:11], s43 offen offset:3072
  s_add_u32 s40, s40, 4096
  s_add_u32 s41, s41, 4096
  s_add_u32 s42, s42, 4096
  s_add_u32 s43, s43, 4096
  buffer_load_dwordx4 a[128:131], v4, s[12:15], s40 offen offset:0
  buffer_load_dwordx4 a[136:139], v4, s[8:11], s42 offen offset:0
  buffer_load_dwordx4 a[132:135], v4, s[12:15], s41 offen offset:0
  buffer_load_dwordx4 a[140:143], v4, s[8:11], s43 offen offset:0
  buffer_load_dwordx4 a[144:147], v4, s[12:15], s40 offen offset:1024
  buffer_load_dwordx4 a[152:155], v4, s[8:11], s42 offen offset:1024
  buffer_load_dwordx4 a[148:151], v4, s[12:15], s41 offen offset:1024
  buffer_load_dwordx4 a[156:159], v4, s[8:11], s43 offen offset:1024
  buffer_load_dwordx4 a[160:163], v4, s[12:15], s40 offen offset:2048
  buffer_load_dwordx4 a[168:171], v4, s[8:11], s42 offen offset:2048
  buffer_load_dwordx4 a[164:167], v4, s[12:15], s41 offen offset:2048
  buffer_load_dwordx4 a[172:175], v4, s[8:11], s43 offen offset:2048
  buffer_load_dwordx4 a[176:179], v4, s[12:15], s40 offen offset:3072
  buffer_load_dwordx4 a[184:187], v4, s[8:11], s42 offen offset:3072
  buffer_load_dwordx4 a[180:183], v4, s[12:15], s41 offen offset:3072
  buffer_load_dwordx4 a[188:191], v4, s[8:11], s43 offen offset:3072
  s_add_u32 s40, s40, 4096
  s_add_u32 s41, s41, 4096
  s_add_u32 s42, s42, 4096
  s_add_u32 s43, s43, 4096
  s_add_u32 s16, s4, 0x840000
  s_addc_u32 s17, s5, 0
  s_mov_b32 s18, 0x200000
  s_mov_b32 s19, 0x20000
  s_lshl_b32 s44, s35, 15
  s_lshl_b32 s45, s33, 11
  s_add_u32 s44, s44, s45
  buffer_load_dwordx4 v[80:83], v4, s[16:19], s44 offen
  buffer_load_dwordx4 v[84:87], v4, s[16:19], s44 offen offset:1024
  v_and_b32 v2, 31, v0
  v_lshrrev_b32 v3, 5, v0
  s_add_u32 s20, s4, 0x600000
  s_addc_u32 s21, s5, 0
  s_mov_b32 s22, 0x200000
  s_mov_b32 s23, 0x20000
  s_add_u32 s24, s4, 0x800000
  s_addc_u32 s25, s5, 0
  s_mov_b32 s26, 0x40000
  s_mov_b32 s27, 0x20000
  v_lshlrev_b32 v5, 7, v2
  s_lshl_b32 s46, s35, 12
  s_lshl_b32 s45, s33, 3
  s_add_u32 s46, s46, s45

  s_xor_b32 s47, s3, 1
  s_mul_i32 s47, s47, 12288
  s_add_u32 s47, s47, 0
  v_add_u32 v9, s47, v4
  s_xor_b32 s47, s3, 2
  s_mul_i32 s47, s47, 12288
  s_add_u32 s47, s47, 4096
  v_add_u32 v10, s47, v4
  s_xor_b32 s47, s3, 3
  s_mul_i32 s47, s47, 12288
  s_add_u32 s47, s47, 8192
  v_add_u32 v11, s47, v4
  s_mul_i32 s47, s3, 12288
  v_add_u32 v8, s47, v4
  s_waitcnt vmcnt(46)
  v_mfma_f32_32x32x16_bf16 v[16:31], a[0:3], a[8:11], 0
  v_mfma_f32_32x32x16_bf16 v[32:47], a[0:3], a[12:15], 0
  v_mfma_f32_32x32x16_bf16 v[48:63], a[4:7], a[8:11], 0
  v_mfma_f32_32x32x16_bf16 v[64:79], a[4:7], a[12:15], 0
  buffer_load_dwordx4 a[0:3], v4, s[12:15], s40 offen offset:0
  buffer_load_dwordx4 a[8:11], v4, s[8:11], s42 offen offset:0
  buffer_load_dwordx4 a[4:7], v4, s[12:15], s41 offen offset:0
  buffer_load_dwordx4 a[12:15], v4, s[8:11], s43 offen offset:0
  s_waitcnt vmcnt(46)
  v_mfma_f32_32x32x16_bf16 v[16:31], a[16:19], a[24:27], v[16:31]
  v_mfma_f32_32x32x16_bf16 v[32:47], a[16:19], a[28:31], v[32:47]
  v_mfma_f32_32x32x16_bf16 v[48:63], a[20:23], a[24:27], v[48:63]
  v_mfma_f32_32x32x16_bf16 v[64:79], a[20:23], a[28:31], v[64:79]
  buffer_load_dwordx4 a[16:19], v4, s[12:15], s40 offen offset:1024
  buffer_load_dwordx4 a[24:27], v4, s[8:11], s42 offen offset:1024
  buffer_load_dwordx4 a[20:23], v4, s[12:15], s41 offen offset:1024
  buffer_load_dwordx4 a[28:31], v4, s[8:11], s43 offen offset:1024
  s_waitcnt vmcnt(46)
  v_mfma_f32_32x32x16_bf16 v[16:31], a[32:35], a[40:43], v[16:31]
  v_mfma_f32_32x32x16_bf16 v[32:47], a[32:35], a[44:47], v[32:47]
  v_mfma_f32_32x32x16_bf16 v[48:63], a[36:39], a[40:43], v[48:63]
  v_mfma_f32_32x32x16_bf16 v[64:79], a[36:39], a[44:47], v[64:79]
  buffer_load_dwordx4 a[32:35], v4, s[12:15], s40 offen offset:2048
  buffer_load_dwordx4 a[40:43], v4, s[8:11], s42 offen offset:2048
  buffer_load_dwordx4 a[36:39], v4, s[12:15], s41 offen offset:2048
  buffer_load_dwordx4 a[44:47], v4, s[8:11], s43 offen offset:2048
  s_waitcnt vmcnt(46)
  v_mfma_f32_32x32x16_bf16 v[16:31], a[48:51], a[56:59], v[16:31]
  v_mfma_f32_32x32x16_bf16 v[32:47], a[48:51], a[60:63], v[32:47]
  v_mfma_f32_32x32x16_bf16 v[48:63], a[52:55], a[56:59], v[48:63]
  v_mfma_f32_32x32x16_bf16 v[64:79], a[52:55], a[60:63], v[64:79]
  buffer_load_dwordx4 a[48:51], v4, s[12:15], s40 offen offset:3072
  buffer_load_dwordx4 a[56:59], v4, s[8:11], s42 offen offset:3072
  buffer_load_dwordx4 a[52:55], v4, s[12:15], s41 offen offset:3072
  buffer_load_dwordx4 a[60:63], v4, s[8:11], s43 offen offset:3072
  s_add_u32 s40, s40, 4096
  s_add_u32 s41, s41, 4096
  s_add_u32 s42, s42, 4096
  s_add_u32 s43, s43, 4096
  s_waitcnt vmcnt(46)
  v_mfma_f32_32x32x16_bf16 v[16:31], a[64:67], a[72:75], v[16:31]
  v_mfma_f32_32x32x16_bf16 v[32:47], a[64:67], a[76:79], v[32:47]
  v_mfma_f32_32x32x16_bf16 v[48:63], a[68:71], a[72:75], v[48:63]
  v_mfma_f32_32x32x16_bf16 v[64:79], a[68:71], a[76:79], v[64:79]
  buffer_load_dwordx4 a[64:67], v4, s[12:15], s40 offen offset:0
  buffer_load_dwordx4 a[72:75], v4, s[8:11], s42 offen offset:0
  buffer_load_dwordx4 a[68:71], v4, s[12:15], s41 offen offset:0
  buffer_load_dwordx4 a[76:79], v4, s[8:11], s43 offen offset:0
  s_waitcnt vmcnt(46)
  v_mfma_f32_32x32x16_bf16 v[16:31], a[80:83], a[88:91], v[16:31]
  v_mfma_f32_32x32x16_bf16 v[32:47], a[80:83], a[92:95], v[32:47]
  v_mfma_f32_32x32x16_bf16 v[48:63], a[84:87], a[88:91], v[48:63]
  v_mfma_f32_32x32x16_bf16 v[64:79], a[84:87], a[92:95], v[64:79]
  buffer_load_dwordx4 a[80:83], v4, s[12:15], s40 offen offset:1024
  buffer_load_dwordx4 a[88:91], v4, s[8:11], s42 offen offset:1024
  buffer_load_dwordx4 a[84:87], v4, s[12:15], s41 offen offset:1024
  buffer_load_dwordx4 a[92:95], v4, s[8:11], s43 offen offset:1024
  s_waitcnt vmcnt(46)
  v_mfma_f32_32x32x16_bf16 v[16:31], a[96:99], a[104:107], v[16:31]
  v_mfma_f32_32x32x16_bf16 v[32:47], a[96:99], a[108:111], v[32:47]
  v_mfma_f32_32x32x16_bf16 v[48:63], a[100:103], a[104:107], v[48:63]
  v_mfma_f32_32x32x16_bf16 v[64:79], a[100:103], a[108:111], v[64:79]
  buffer_load_dwordx4 a[96:99], v4, s[12:15], s40 offen offset:2048
  buffer_load_dwordx4 a[104:107], v4, s[8:11], s42 offen offset:2048
  buffer_load_dwordx4 a[100:103], v4, s[12:15], s41 offen offset:2048
  buffer_load_dwordx4 a[108:111], v4, s[8:11], s43 offen offset:2048
  s_waitcnt vmcnt(46)
  v_mfma_f32_32x32x16_bf16 v[16:31], a[112:115], a[120:123], v[16:31]
  v_mfma_f32_32x32x16_bf16 v[32:47], a[112:115], a[124:127], v[32:47]
  v_mfma_f32_32x32x16_bf16 v[48:63], a[116:119], a[120:123], v[48:63]
  v_mfma_f32_32x32x16_bf16 v[64:79], a[116:119], a[124:127], v[64:79]
  buffer_load_dwordx4 a[112:115], v4, s[12:15], s40 offen offset:3072
  buffer_load_dwordx4 a[120:123], v4, s[8:11], s42 offen offset:3072
  buffer_load_dwordx4 a[116:119], v4, s[12:15], s41 offen offset:3072
  buffer_load_dwordx4 a[124:127], v4, s[8:11], s43 offen offset:3072
  s_add_u32 s40, s40, 4096
  s_add_u32 s41, s41, 4096
  s_add_u32 s42, s42, 4096
  s_add_u32 s43, s43, 4096
  s_waitcnt vmcnt(46)
  v_mfma_f32_32x32x16_bf16 v[16:31], a[128:131], a[136:139], v[16:31]
  v_mfma_f32_32x32x16_bf16 v[32:47], a[128:131], a[140:143], v[32:47]
  v_mfma_f32_32x32x16_bf16 v[48:63], a[132:135], a[136:139], v[48:63]
  v_mfma_f32_32x32x16_bf16 v[64:79], a[132:135], a[140:143], v[64:79]
  buffer_load_dwordx4 a[128:131], v4, s[12:15], s40 offen offset:0
  buffer_load_dwordx4 a[136:139], v4, s[8:11], s42 offen offset:0
  buffer_load_dwordx4 a[132:135], v4, s[12:15], s41 offen offset:0
  buffer_load_dwordx4 a[140:143], v4, s[8:11], s43 offen offset:0
  s_waitcnt vmcnt(46)
  v_mfma_f32_32x32x16_bf16 v[16:31], a[144:147], a[152:155], v[16:31]
  v_mfma_f32_32x32x16_bf16 v[32:47], a[144:147], a[156:159], v[32:47]
  v_mfma_f32_32x32x16_bf16 v[48:63], a[148:151], a[152:155], v[48:63]
  v_mfma_f32_32x32x16_bf16 v[64:79], a[148:151], a[156:159], v[64:79]
  buffer_load_dwordx4 a[144:147], v4, s[12:15], s40 offen offset:1024
  buffer_load_dwordx4 a[152:155], v4, s[8:11], s42 offen offset:1024
  buffer_load_dwordx4 a[148:151], v4, s[12:15], s41 offen offset:1024
  buffer_load_dwordx4 a[156:159], v4, s[8:11], s43 offen offset:1024
  s_waitcnt vmcnt(46)
  v_mfma_f32_32x32x16_bf16 v[16:31], a[160:163], a[168:171], v[16:31]
  v_mfma_f32_32x32x16_bf16 v[32:47], a[160:163], a[172:175], v[32:47]
  v_mfma_f32_32x32x16_bf16 v[48:63], a[164:167], a[168:171], v[48:63]
  v_mfma_f32_32x32x16_bf16 v[64:79], a[164:167], a[172:175], v[64:79]
  buffer_load_dwordx4 a[160:163], v4, s[12:15], s40 offen offset:2048
  buffer_load_dwordx4 a[168:171], v4, s[8:11], s42 offen offset:2048
  buffer_load_dwordx4 a[164:167], v4, s[12:15], s41 offen offset:2048
  buffer_load_dwordx4 a[172:175], v4, s[8:11], s43 offen offset:2048
  s_waitcnt vmcnt(46)
  v_mfma_f32_32x32x16_bf16 v[16:31], a[176:179], a[184:187], v[16:31]
  v_mfma_f32_32x32x16_bf16 v[32:47], a[176:179], a[188:191], v[32:47]
  v_mfma_f32_32x32x16_bf16 v[48:63], a[180:183], a[184:187], v[48:63]
  v_mfma_f32_32x32x16_bf16 v[64:79], a[180:183], a[188:191], v[64:79]
  buffer_load_dwordx4 a[176:179], v4, s[12:15], s40 offen offset:3072
  buffer_load_dwordx4 a[184:187], v4, s[8:11], s42 offen offset:3072
  buffer_load_dwordx4 a[180:183], v4, s[12:15], s41 offen offset:3072
  buffer_load_dwordx4 a[188:191], v4, s[8:11], s43 offen offset:3072
  s_add_u32 s40, s40, 4096
  s_add_u32 s41, s41, 4096
  s_add_u32 s42, s42, 4096
  s_add_u32 s43, s43, 4096
  s_waitcnt vmcnt(44)
  v_mfma_f32_32x32x16_bf16 v[16:31], a[0:3], a[8:11], v[16:31]
  v_mfma_f32_32x32x16_bf16 v[32:47], a[0:3], a[12:15], v[32:47]
  v_mfma_f32_32x32x16_bf16 v[48:63], a[4:7], a[8:11], v[48:63]
  v_mfma_f32_32x32x16_bf16 v[64:79], a[4:7], a[12:15], v[64:79]
  buffer_load_dwordx4 a[0:3], v4, s[12:15], s40 offen offset:0
  buffer_load_dwordx4 a[8:11], v4, s[8:11], s42 offen offset:0
  buffer_load_dwordx4 a[4:7], v4, s[12:15], s41 offen offset:0
  buffer_load_dwordx4 a[12:15], v4, s[8:11], s43 offen offset:0
  s_waitcnt vmcnt(44)
  v_mfma_f32_32x32x16_bf16 v[16:31], a[16:19], a[24:27], v[16:31]
  v_mfma_f32_32x32x16_bf16 v[32:47], a[16:19], a[28:31], v[32:47]
  v_mfma_f32_32x32x16_bf16 v[48:63], a[20:23], a[24:27], v[48:63]
  v_mfma_f32_32x32x16_bf16 v[64:79], a[20:23], a[28:31], v[64:79]
  buffer_load_dwordx4 a[16:19], v4, s[12:15], s40 offen offset:1024
  buffer_load_dwordx4 a[24:27], v4, s[8:11], s42 offen offset:1024
  buffer_load_dwordx4 a[20:23], v4, s[12:15], s41 offen offset:1024
  buffer_load_dwordx4 a[28:31], v4, s[8:11], s43 offen offset:1024
  s_waitcnt vmcnt(44)
  v_mfma_f32_32x32x16_bf16 v[16:31], a[32:35], a[40:43], v[16:31]
  v_mfma_f32_32x32x16_bf16 v[32:47], a[32:35], a[44:47], v[32:47]
  v_mfma_f32_32x32x16_bf16 v[48:63], a[36:39], a[40:43], v[48:63]
  v_mfma_f32_32x32x16_bf16 v[64:79], a[36:39], a[44:47], v[64:79]
  buffer_load_dwordx4 a[32:35], v4, s[12:15], s40 offen offset:2048
  buffer_load_dwordx4 a[40:43], v4, s[8:11], s42 offen offset:2048
  buffer_load_dwordx4 a[36:39], v4, s[12:15], s41 offen offset:2048
  buffer_load_dwordx4 a[44:47], v4, s[8:11], s43 offen offset:2048
  s_waitcnt vmcnt(44)
  v_mfma_f32_32x32x16_bf16 v[16:31], a[48:51], a[56:59], v[16:31]
  v_mfma_f32_32x32x16_bf16 v[32:47], a[48:51], a[60:63], v[32:47]
  v_mfma_f32_32x32x16_bf16 v[48:63], a[52:55], a[56:59], v[48:63]
  v_mfma_f32_32x32x16_bf16 v[64:79], a[52:55], a[60:63], v[64:79]
  buffer_load_dwordx4 a[48:51], v4, s[12:15], s40 offen offset:3072
  buffer_load_dwordx4 a[56:59], v4, s[8:11], s42 offen offset:3072
  buffer_load_dwordx4 a[52:55], v4, s[12:15], s41 offen offset:3072
  buffer_load_dwordx4 a[60:63], v4, s[8:11], s43 offen offset:3072
  s_waitcnt vmcnt(44)
  v_mfma_f32_32x32x16_bf16 v[16:31], a[64:67], a[72:75], v[16:31]
  v_mfma_f32_32x32x16_bf16 v[32:47], a[64:67], a[76:79], v[32:47]
  v_mfma_f32_32x32x16_bf16 v[48:63], a[68:71], a[72:75], v[48:63]
  v_mfma_f32_32x32x16_bf16 v[64:79], a[68:71], a[76:79], v[64:79]
  s_waitcnt vmcnt(40)
  v_mfma_f32_32x32x16_bf16 v[16:31], a[80:83], a[88:91], v[16:31]
  v_mfma_f32_32x32x16_bf16 v[32:47], a[80:83], a[92:95], v[32:47]
  v_mfma_f32_32x32x16_bf16 v[48:63], a[84:87], a[88:91], v[48:63]
  v_mfma_f32_32x32x16_bf16 v[64:79], a[84:87], a[92:95], v[64:79]
  s_waitcnt vmcnt(36)
  v_mfma_f32_32x32x16_bf16 v[16:31], a[96:99], a[104:107], v[16:31]
  v_mfma_f32_32x32x16_bf16 v[32:47], a[96:99], a[108:111], v[32:47]
  v_mfma_f32_32x32x16_bf16 v[48:63], a[100:103], a[104:107], v[48:63]
  v_mfma_f32_32x32x16_bf16 v[64:79], a[100:103], a[108:111], v[64:79]
  s_waitcnt vmcnt(32)
  v_mfma_f32_32x32x16_bf16 v[16:31], a[112:115], a[120:123], v[16:31]
  v_mfma_f32_32x32x16_bf16 v[32:47], a[112:115], a[124:127], v[32:47]
  v_mfma_f32_32x32x16_bf16 v[48:63], a[116:119], a[120:123], v[48:63]
  v_mfma_f32_32x32x16_bf16 v[64:79], a[116:119], a[124:127], v[64:79]
  s_waitcnt vmcnt(28)
  v_mfma_f32_32x32x16_bf16 v[16:31], a[128:131], a[136:139], v[16:31]
  v_mfma_f32_32x32x16_bf16 v[32:47], a[128:131], a[140:143], v[32:47]
  v_mfma_f32_32x32x16_bf16 v[48:63], a[132:135], a[136:139], v[48:63]
  v_mfma_f32_32x32x16_bf16 v[64:79], a[132:135], a[140:143], v[64:79]
  s_waitcnt vmcnt(24)
  v_mfma_f32_32x32x16_bf16 v[16:31], a[144:147], a[152:155], v[16:31]
  v_mfma_f32_32x32x16_bf16 v[32:47], a[144:147], a[156:159], v[32:47]
  v_mfma_f32_32x32x16_bf16 v[48:63], a[148:151], a[152:155], v[48:63]
  v_mfma_f32_32x32x16_bf16 v[64:79], a[148:151], a[156:159], v[64:79]
  s_waitcnt vmcnt(20)
  v_mfma_f32_32x32x16_bf16 v[16:31], a[160:163], a[168:171], v[16:31]
  v_mfma_f32_32x32x16_bf16 v[32:47], a[160:163], a[172:175], v[32:47]
  v_mfma_f32_32x32x16_bf16 v[48:63], a[164:167], a[168:171], v[48:63]
  v_mfma_f32_32x32x16_bf16 v[64:79], a[164:167], a[172:175], v[64:79]
  s_waitcnt vmcnt(16)
  v_mfma_f32_32x32x16_bf16 v[16:31], a[176:179], a[184:187], v[16:31]
  v_mfma_f32_32x32x16_bf16 v[32:47], a[176:179], a[188:191], v[32:47]
  v_mfma_f32_32x32x16_bf16 v[48:63], a[180:183], a[184:187], v[48:63]
  v_mfma_f32_32x32x16_bf16 v[64:79], a[180:183], a[188:191], v[64:79]
  s_waitcnt vmcnt(12)
  v_mfma_f32_32x32x16_bf16 v[16:31], a[0:3], a[8:11], v[16:31]
  v_mfma_f32_32x32x16_bf16 v[32:47], a[0:3], a[12:15], v[32:47]
  v_mfma_f32_32x32x16_bf16 v[48:63], a[4:7], a[8:11], v[48:63]
  v_mfma_f32_32x32x16_bf16 v[64:79], a[4:7], a[12:15], v[64:79]
  s_waitcnt vmcnt(8)
  v_mfma_f32_32x32x16_bf16 v[16:31], a[16:19], a[24:27], v[16:31]
  v_mfma_f32_32x32x16_bf16 v[32:47], a[16:19], a[28:31], v[32:47]
  v_mfma_f32_32x32x16_bf16 v[48:63], a[20:23], a[24:27], v[48:63]
  v_mfma_f32_32x32x16_bf16 v[64:79], a[20:23], a[28:31], v[64:79]
  s_waitcnt vmcnt(4)
  v_mfma_f32_32x32x16_bf16 v[16:31], a[32:35], a[40:43], v[16:31]
  v_mfma_f32_32x32x16_bf16 v[32:47], a[32:35], a[44:47], v[32:47]
  v_mfma_f32_32x32x16_bf16 v[48:63], a[36:39], a[40:43], v[48:63]
  v_mfma_f32_32x32x16_bf16 v[64:79], a[36:39], a[44:47], v[64:79]
  s_waitcnt vmcnt(0)
  v_mfma_f32_32x32x16_bf16 v[16:31], a[48:51], a[56:59], v[16:31]
  v_mfma_f32_32x32x16_bf16 v[32:47], a[48:51], a[60:63], v[32:47]
  v_mfma_f32_32x32x16_bf16 v[48:63], a[52:55], a[56:59], v[48:63]
  v_mfma_f32_32x32x16_bf16 v[64:79], a[52:55], a[60:63], v[64:79]
  s_nop 9
  ds_write_b128 v9, v[32:35] offset:0
  ds_write_b128 v9, v[36:39] offset:1024
  ds_write_b128 v9, v[40:43] offset:2048
  ds_write_b128 v9, v[44:47] offset:3072
  ds_write_b128 v10, v[48:51] offset:0
  ds_write_b128 v10, v[52:55] offset:1024
  ds_write_b128 v10, v[56:59] offset:2048
  ds_write_b128 v10, v[60:63] offset:3072
  s_nop 3
  ds_write_b128 v11, v[64:67] offset:0
  ds_write_b128 v11, v[68:71] offset:1024
  ds_write_b128 v11, v[72:75] offset:2048
  ds_write_b128 v11, v[76:79] offset:3072
  s_waitcnt lgkmcnt(0)
  s_barrier
  ds_read_b128 v[32:35], v8 offset:0
  ds_read_b128 v[36:39], v8 offset:1024
  ds_read_b128 v[40:43], v8 offset:2048
  ds_read_b128 v[44:47], v8 offset:3072
  ds_read_b128 v[48:51], v8 offset:4096
  ds_read_b128 v[52:55], v8 offset:5120
  ds_read_b128 v[56:59], v8 offset:6144
  ds_read_b128 v[60:63], v8 offset:7168
  ds_read_b128 v[64:67], v8 offset:8192
  ds_read_b128 v[68:71], v8 offset:9216
  ds_read_b128 v[72:75], v8 offset:10240
  ds_read_b128 v[76:79], v8 offset:11264
  v_lshlrev_b32 v96, 16, v80
  v_and_b32 v97, 0xffff0000, v80
  v_add_f32 v16, v16, v96
  v_add_f32 v17, v17, v97
  v_lshlrev_b32 v96, 16, v81
  v_and_b32 v97, 0xffff0000, v81
  v_add_f32 v18, v18, v96
  v_add_f32 v19, v19, v97
  v_lshlrev_b32 v96, 16, v82
  v_and_b32 v97, 0xffff0000, v82
  v_add_f32 v20, v20, v96
  v_add_f32 v21, v21, v97
  v_lshlrev_b32 v96, 16, v83
  v_and_b32 v97, 0xffff0000, v83
  v_add_f32 v22, v22, v96
  v_add_f32 v23, v23, v97
  v_lshlrev_b32 v96, 16, v84
  v_and_b32 v97, 0xffff0000, v84
  v_add_f32 v24, v24, v96
  v_add_f32 v25, v25, v97
  v_lshlrev_b32 v96, 16, v85
  v_and_b32 v97, 0xffff0000, v85
  v_add_f32 v26, v26, v96
  v_add_f32 v27, v27, v97
  v_lshlrev_b32 v96, 16, v86
  v_and_b32 v97, 0xffff0000, v86
  v_add_f32 v28, v28, v96
  v_add_f32 v29, v29, v97
  v_lshlrev_b32 v96, 16, v87
  v_and_b32 v97, 0xffff0000, v87
  v_add_f32 v30, v30, v96
  v_add_f32 v31, v31, v97
  s_waitcnt lgkmcnt(8)
  v_add_f32 v16, v16, v32
  v_add_f32 v17, v17, v33
  v_add_f32 v18, v18, v34
  v_add_f32 v19, v19, v35
  v_add_f32 v20, v20, v36
  v_add_f32 v21, v21, v37
  v_add_f32 v22, v22, v38
  v_add_f32 v23, v23, v39
  v_add_f32 v24, v24, v40
  v_add_f32 v25, v25, v41
  v_add_f32 v26, v26, v42
  v_add_f32 v27, v27, v43
  v_add_f32 v28, v28, v44
  v_add_f32 v29, v29, v45
  v_add_f32 v30, v30, v46
  v_add_f32 v31, v31, v47
  s_waitcnt lgkmcnt(4)
  v_add_f32 v16, v16, v48
  v_add_f32 v17, v17, v49
  v_add_f32 v18, v18, v50
  v_add_f32 v19, v19, v51
  v_add_f32 v20, v20, v52
  v_add_f32 v21, v21, v53
  v_add_f32 v22, v22, v54
  v_add_f32 v23, v23, v55
  v_add_f32 v24, v24, v56
  v_add_f32 v25, v25, v57
  v_add_f32 v26, v26, v58
  v_add_f32 v27, v27, v59
  v_add_f32 v28, v28, v60
  v_add_f32 v29, v29, v61
  v_add_f32 v30, v30, v62
  v_add_f32 v31, v31, v63
  s_waitcnt lgkmcnt(0)
  v_add_f32 v16, v16, v64
  v_add_f32 v17, v17, v65
  v_add_f32 v18, v18, v66
  v_add_f32 v19, v19, v67
  v_add_f32 v20, v20, v68
  v_add_f32 v21, v21, v69
  v_add_f32 v22, v22, v70
  v_add_f32 v23, v23, v71
  v_add_f32 v24, v24, v72
  v_add_f32 v25, v25, v73
  v_add_f32 v26, v26, v74
  v_add_f32 v27, v27, v75
  v_add_f32 v28, v28, v76
  v_add_f32 v29, v29, v77
  v_add_f32 v30, v30, v78
  v_add_f32 v31, v31, v79
  v_cvt_pk_bf16_f32 v88, v16, v17
  v_cvt_pk_bf16_f32 v89, v18, v19
  v_cvt_pk_bf16_f32 v90, v20, v21
  v_cvt_pk_bf16_f32 v91, v22, v23
  v_cvt_pk_bf16_f32 v92, v24, v25
  v_cvt_pk_bf16_f32 v93, v26, v27
  v_cvt_pk_bf16_f32 v94, v28, v29
  v_cvt_pk_bf16_f32 v95, v30, v31
  buffer_store_dwordx4 v[88:91], v4, s[20:23], s44 offen sc1
  buffer_store_dwordx4 v[92:95], v4, s[20:23], s44 offen offset:1024 sc1
  v_mov_b32 v12, 0
  v_mov_b32 v13, 0
  s_mov_b32 s47, 0x3f803f80
  v_dot2_f32_bf16 v12, v88, s47, v12
  v_dot2_f32_bf16 v13, v88, v88, v13
  v_dot2_f32_bf16 v12, v89, s47, v12
  v_dot2_f32_bf16 v13, v89, v89, v13
  v_dot2_f32_bf16 v12, v90, s47, v12
  v_dot2_f32_bf16 v13, v90, v90, v13
  v_dot2_f32_bf16 v12, v91, s47, v12
  v_dot2_f32_bf16 v13, v91, v91, v13
  v_dot2_f32_bf16 v12, v92, s47, v12
  v_dot2_f32_bf16 v13, v92, v92, v13
  v_dot2_f32_bf16 v12, v93, s47, v12
  v_dot2_f32_bf16 v13, v93, v93, v13
  v_dot2_f32_bf16 v12, v94, s47, v12
  v_dot2_f32_bf16 v13, v94, v94, v13
  v_dot2_f32_bf16 v12, v95, s47, v12
  v_dot2_f32_bf16 v13, v95, v95, v13
  s_nop 3
  v_mov_b32 v14, v12
  v_mov_b32 v15, v13
  s_nop 1
  v_permlane32_swap_b32 v12, v14
  v_permlane32_swap_b32 v13, v15
  s_nop 1
  v_add_f32 v12, v12, v14
  v_add_f32 v13, v13, v15
  buffer_store_dwordx2 v[12:13], v5, s[24:27], s46 offen

ffn2_kernel_exit:
  s_endpgm
.text
.globl ffn2_last_kernel
.p2align 8
.type ffn2_last_kernel,@function
ffn2_last_kernel:
  s_cmp_ge_u32 s2, 256
  s_cbranch_scc1 ffn2_last_kernel_exit
  s_load_dwordx2 s[4:5], s[0:1], 64
  s_load_dwordx2 s[6:7], s[0:1], 48
  v_lshrrev_b32 v1, 6, v0
  v_and_b32 v0, 63, v0
  s_and_b32 s28, s2, 7
  v_readfirstlane_b32 s3, v1
  s_lshl_b32 s28, s28, 2
  s_bfe_u32 s29, s2, 0x20003
  s_add_u32 s28, s28, s29
  s_lshr_b32 s29, s2, 5
  v_lshlrev_b32 v4, 4, v0
  s_lshr_b32 s30, s3, 1
  s_and_b32 s31, s3, 1
  s_lshl_b32 s32, s29, 1
  s_add_u32 s33, s32, s30
  s_xor_b32 s34, s33, 1
  s_lshl_b32 s32, s28, 1
  s_add_u32 s35, s32, s31
  s_xor_b32 s36, s35, 1
  s_mul_i32 s37, s3, 28672
  s_mul_i32 s40, s33, 114688
  s_mul_i32 s41, s34, 114688
  s_mul_i32 s42, s35, 114688
  s_mul_i32 s43, s36, 114688
  s_add_u32 s40, s40, s37
  s_add_u32 s41, s41, s37
  s_add_u32 s42, s42, s37
  s_add_u32 s43, s43, s37
  s_waitcnt lgkmcnt(0)

  s_add_u32 s8, s4, 0x1280000
  s_addc_u32 s9, s5, 0
  s_mov_b32 s10, 0x700000
  s_mov_b32 s11, 0x20000
  s_add_u32 s12, s4, 0x3e0000
  s_addc_u32 s13, s5, 0
  s_mov_b32 s14, 0x1c0000
  s_mov_b32 s15, 0x20000
  buffer_load_dwordx4 a[0:3], v4, s[12:15], s40 offen offset:0
  buffer_load_dwordx4 a[8:11], v4, s[8:11], s42 offen offset:0
  buffer_load_dwordx4 a[4:7], v4, s[12:15], s41 offen offset:0
  buffer_load_dwordx4 a[12:15], v4, s[8:11], s43 offen offset:0
  buffer_load_dwordx4 a[16:19], v4, s[12:15], s40 offen offset:1024
  buffer_load_dwordx4 a[24:27], v4, s[8:11], s42 offen offset:1024
  buffer_load_dwordx4 a[20:23], v4, s[12:15], s41 offen offset:1024
  buffer_load_dwordx4 a[28:31], v4, s[8:11], s43 offen offset:1024
  buffer_load_dwordx4 a[32:35], v4, s[12:15], s40 offen offset:2048
  buffer_load_dwordx4 a[40:43], v4, s[8:11], s42 offen offset:2048
  buffer_load_dwordx4 a[36:39], v4, s[12:15], s41 offen offset:2048
  buffer_load_dwordx4 a[44:47], v4, s[8:11], s43 offen offset:2048
  buffer_load_dwordx4 a[48:51], v4, s[12:15], s40 offen offset:3072
  buffer_load_dwordx4 a[56:59], v4, s[8:11], s42 offen offset:3072
  buffer_load_dwordx4 a[52:55], v4, s[12:15], s41 offen offset:3072
  buffer_load_dwordx4 a[60:63], v4, s[8:11], s43 offen offset:3072
  s_add_u32 s40, s40, 4096
  s_add_u32 s41, s41, 4096
  s_add_u32 s42, s42, 4096
  s_add_u32 s43, s43, 4096
  buffer_load_dwordx4 a[64:67], v4, s[12:15], s40 offen offset:0
  buffer_load_dwordx4 a[72:75], v4, s[8:11], s42 offen offset:0
  buffer_load_dwordx4 a[68:71], v4, s[12:15], s41 offen offset:0
  buffer_load_dwordx4 a[76:79], v4, s[8:11], s43 offen offset:0
  buffer_load_dwordx4 a[80:83], v4, s[12:15], s40 offen offset:1024
  buffer_load_dwordx4 a[88:91], v4, s[8:11], s42 offen offset:1024
  buffer_load_dwordx4 a[84:87], v4, s[12:15], s41 offen offset:1024
  buffer_load_dwordx4 a[92:95], v4, s[8:11], s43 offen offset:1024
  buffer_load_dwordx4 a[96:99], v4, s[12:15], s40 offen offset:2048
  buffer_load_dwordx4 a[104:107], v4, s[8:11], s42 offen offset:2048
  buffer_load_dwordx4 a[100:103], v4, s[12:15], s41 offen offset:2048
  buffer_load_dwordx4 a[108:111], v4, s[8:11], s43 offen offset:2048
  buffer_load_dwordx4 a[112:115], v4, s[12:15], s40 offen offset:3072
  buffer_load_dwordx4 a[120:123], v4, s[8:11], s42 offen offset:3072
  buffer_load_dwordx4 a[116:119], v4, s[12:15], s41 offen offset:3072
  buffer_load_dwordx4 a[124:127], v4, s[8:11], s43 offen offset:3072
  s_add_u32 s40, s40, 4096
  s_add_u32 s41, s41, 4096
  s_add_u32 s42, s42, 4096
  s_add_u32 s43, s43, 4096
  buffer_load_dwordx4 a[128:131], v4, s[12:15], s40 offen offset:0
  buffer_load_dwordx4 a[136:139], v4, s[8:11], s42 offen offset:0
  buffer_load_dwordx4 a[132:135], v4, s[12:15], s41 offen offset:0
  buffer_load_dwordx4 a[140:143], v4, s[8:11], s43 offen offset:0
  buffer_load_dwordx4 a[144:147], v4, s[12:15], s40 offen offset:1024
  buffer_load_dwordx4 a[152:155], v4, s[8:11], s42 offen offset:1024
  buffer_load_dwordx4 a[148:151], v4, s[12:15], s41 offen offset:1024
  buffer_load_dwordx4 a[156:159], v4, s[8:11], s43 offen offset:1024
  buffer_load_dwordx4 a[160:163], v4, s[12:15], s40 offen offset:2048
  buffer_load_dwordx4 a[168:171], v4, s[8:11], s42 offen offset:2048
  buffer_load_dwordx4 a[164:167], v4, s[12:15], s41 offen offset:2048
  buffer_load_dwordx4 a[172:175], v4, s[8:11], s43 offen offset:2048
  buffer_load_dwordx4 a[176:179], v4, s[12:15], s40 offen offset:3072
  buffer_load_dwordx4 a[184:187], v4, s[8:11], s42 offen offset:3072
  buffer_load_dwordx4 a[180:183], v4, s[12:15], s41 offen offset:3072
  buffer_load_dwordx4 a[188:191], v4, s[8:11], s43 offen offset:3072
  s_add_u32 s40, s40, 4096
  s_add_u32 s41, s41, 4096
  s_add_u32 s42, s42, 4096
  s_add_u32 s43, s43, 4096
  s_add_u32 s16, s4, 0x840000
  s_addc_u32 s17, s5, 0
  s_mov_b32 s18, 0x200000
  s_mov_b32 s19, 0x20000
  s_lshl_b32 s44, s35, 15
  s_lshl_b32 s45, s33, 11
  s_add_u32 s44, s44, s45
  buffer_load_dwordx4 v[80:83], v4, s[16:19], s44 offen
  buffer_load_dwordx4 v[84:87], v4, s[16:19], s44 offen offset:1024
  v_and_b32 v2, 31, v0
  v_lshrrev_b32 v3, 5, v0
  s_mov_b32 s20, s6
  s_mov_b32 s21, s7
  s_mov_b32 s22, 2097152
  s_mov_b32 s23, 0x20000
  v_lshlrev_b32 v5, 10, v2
  v_lshl_add_u32 v5, v3, 4, v5
  s_lshl_b32 s46, s35, 15
  s_lshl_b32 s45, s33, 6
  s_add_u32 s46, s46, s45

  s_xor_b32 s47, s3, 1
  s_mul_i32 s47, s47, 12288
  s_add_u32 s47, s47, 0
  v_add_u32 v9, s47, v4
  s_xor_b32 s47, s3, 2
  s_mul_i32 s47, s47, 12288
  s_add_u32 s47, s47, 4096
  v_add_u32 v10, s47, v4
  s_xor_b32 s47, s3, 3
  s_mul_i32 s47, s47, 12288
  s_add_u32 s47, s47, 8192
  v_add_u32 v11, s47, v4
  s_mul_i32 s47, s3, 12288
  v_add_u32 v8, s47, v4
  s_waitcnt vmcnt(46)
  v_mfma_f32_32x32x16_bf16 v[16:31], a[0:3], a[8:11], 0
  v_mfma_f32_32x32x16_bf16 v[32:47], a[0:3], a[12:15], 0
  v_mfma_f32_32x32x16_bf16 v[48:63], a[4:7], a[8:11], 0
  v_mfma_f32_32x32x16_bf16 v[64:79], a[4:7], a[12:15], 0
  buffer_load_dwordx4 a[0:3], v4, s[12:15], s40 offen offset:0
  buffer_load_dwordx4 a[8:11], v4, s[8:11], s42 offen offset:0
  buffer_load_dwordx4 a[4:7], v4, s[12:15], s41 offen offset:0
  buffer_load_dwordx4 a[12:15], v4, s[8:11], s43 offen offset:0
  s_waitcnt vmcnt(46)
  v_mfma_f32_32x32x16_bf16 v[16:31], a[16:19], a[24:27], v[16:31]
  v_mfma_f32_32x32x16_bf16 v[32:47], a[16:19], a[28:31], v[32:47]
  v_mfma_f32_32x32x16_bf16 v[48:63], a[20:23], a[24:27], v[48:63]
  v_mfma_f32_32x32x16_bf16 v[64:79], a[20:23], a[28:31], v[64:79]
  buffer_load_dwordx4 a[16:19], v4, s[12:15], s40 offen offset:1024
  buffer_load_dwordx4 a[24:27], v4, s[8:11], s42 offen offset:1024
  buffer_load_dwordx4 a[20:23], v4, s[12:15], s41 offen offset:1024
  buffer_load_dwordx4 a[28:31], v4, s[8:11], s43 offen offset:1024
  s_waitcnt vmcnt(46)
  v_mfma_f32_32x32x16_bf16 v[16:31], a[32:35], a[40:43], v[16:31]
  v_mfma_f32_32x32x16_bf16 v[32:47], a[32:35], a[44:47], v[32:47]
  v_mfma_f32_32x32x16_bf16 v[48:63], a[36:39], a[40:43], v[48:63]
  v_mfma_f32_32x32x16_bf16 v[64:79], a[36:39], a[44:47], v[64:79]
  buffer_load_dwordx4 a[32:35], v4, s[12:15], s40 offen offset:2048
  buffer_load_dwordx4 a[40:43], v4, s[8:11], s42 offen offset:2048
  buffer_load_dwordx4 a[36:39], v4, s[12:15], s41 offen offset:2048
  buffer_load_dwordx4 a[44:47], v4, s[8:11], s43 offen offset:2048
  s_waitcnt vmcnt(46)
  v_mfma_f32_32x32x16_bf16 v[16:31], a[48:51], a[56:59], v[16:31]
  v_mfma_f32_32x32x16_bf16 v[32:47], a[48:51], a[60:63], v[32:47]
  v_mfma_f32_32x32x16_bf16 v[48:63], a[52:55], a[56:59], v[48:63]
  v_mfma_f32_32x32x16_bf16 v[64:79], a[52:55], a[60:63], v[64:79]
  buffer_load_dwordx4 a[48:51], v4, s[12:15], s40 offen offset:3072
  buffer_load_dwordx4 a[56:59], v4, s[8:11], s42 offen offset:3072
  buffer_load_dwordx4 a[52:55], v4, s[12:15], s41 offen offset:3072
  buffer_load_dwordx4 a[60:63], v4, s[8:11], s43 offen offset:3072
  s_add_u32 s40, s40, 4096
  s_add_u32 s41, s41, 4096
  s_add_u32 s42, s42, 4096
  s_add_u32 s43, s43, 4096
  s_waitcnt vmcnt(46)
  v_mfma_f32_32x32x16_bf16 v[16:31], a[64:67], a[72:75], v[16:31]
  v_mfma_f32_32x32x16_bf16 v[32:47], a[64:67], a[76:79], v[32:47]
  v_mfma_f32_32x32x16_bf16 v[48:63], a[68:71], a[72:75], v[48:63]
  v_mfma_f32_32x32x16_bf16 v[64:79], a[68:71], a[76:79], v[64:79]
  buffer_load_dwordx4 a[64:67], v4, s[12:15], s40 offen offset:0
  buffer_load_dwordx4 a[72:75], v4, s[8:11], s42 offen offset:0
  buffer_load_dwordx4 a[68:71], v4, s[12:15], s41 offen offset:0
  buffer_load_dwordx4 a[76:79], v4, s[8:11], s43 offen offset:0
  s_waitcnt vmcnt(46)
  v_mfma_f32_32x32x16_bf16 v[16:31], a[80:83], a[88:91], v[16:31]
  v_mfma_f32_32x32x16_bf16 v[32:47], a[80:83], a[92:95], v[32:47]
  v_mfma_f32_32x32x16_bf16 v[48:63], a[84:87], a[88:91], v[48:63]
  v_mfma_f32_32x32x16_bf16 v[64:79], a[84:87], a[92:95], v[64:79]
  buffer_load_dwordx4 a[80:83], v4, s[12:15], s40 offen offset:1024
  buffer_load_dwordx4 a[88:91], v4, s[8:11], s42 offen offset:1024
  buffer_load_dwordx4 a[84:87], v4, s[12:15], s41 offen offset:1024
  buffer_load_dwordx4 a[92:95], v4, s[8:11], s43 offen offset:1024
  s_waitcnt vmcnt(46)
  v_mfma_f32_32x32x16_bf16 v[16:31], a[96:99], a[104:107], v[16:31]
  v_mfma_f32_32x32x16_bf16 v[32:47], a[96:99], a[108:111], v[32:47]
  v_mfma_f32_32x32x16_bf16 v[48:63], a[100:103], a[104:107], v[48:63]
  v_mfma_f32_32x32x16_bf16 v[64:79], a[100:103], a[108:111], v[64:79]
  buffer_load_dwordx4 a[96:99], v4, s[12:15], s40 offen offset:2048
  buffer_load_dwordx4 a[104:107], v4, s[8:11], s42 offen offset:2048
  buffer_load_dwordx4 a[100:103], v4, s[12:15], s41 offen offset:2048
  buffer_load_dwordx4 a[108:111], v4, s[8:11], s43 offen offset:2048
  s_waitcnt vmcnt(46)
  v_mfma_f32_32x32x16_bf16 v[16:31], a[112:115], a[120:123], v[16:31]
  v_mfma_f32_32x32x16_bf16 v[32:47], a[112:115], a[124:127], v[32:47]
  v_mfma_f32_32x32x16_bf16 v[48:63], a[116:119], a[120:123], v[48:63]
  v_mfma_f32_32x32x16_bf16 v[64:79], a[116:119], a[124:127], v[64:79]
  buffer_load_dwordx4 a[112:115], v4, s[12:15], s40 offen offset:3072
  buffer_load_dwordx4 a[120:123], v4, s[8:11], s42 offen offset:3072
  buffer_load_dwordx4 a[116:119], v4, s[12:15], s41 offen offset:3072
  buffer_load_dwordx4 a[124:127], v4, s[8:11], s43 offen offset:3072
  s_add_u32 s40, s40, 4096
  s_add_u32 s41, s41, 4096
  s_add_u32 s42, s42, 4096
  s_add_u32 s43, s43, 4096
  s_waitcnt vmcnt(46)
  v_mfma_f32_32x32x16_bf16 v[16:31], a[128:131], a[136:139], v[16:31]
  v_mfma_f32_32x32x16_bf16 v[32:47], a[128:131], a[140:143], v[32:47]
  v_mfma_f32_32x32x16_bf16 v[48:63], a[132:135], a[136:139], v[48:63]
  v_mfma_f32_32x32x16_bf16 v[64:79], a[132:135], a[140:143], v[64:79]
  buffer_load_dwordx4 a[128:131], v4, s[12:15], s40 offen offset:0
  buffer_load_dwordx4 a[136:139], v4, s[8:11], s42 offen offset:0
  buffer_load_dwordx4 a[132:135], v4, s[12:15], s41 offen offset:0
  buffer_load_dwordx4 a[140:143], v4, s[8:11], s43 offen offset:0
  s_waitcnt vmcnt(46)
  v_mfma_f32_32x32x16_bf16 v[16:31], a[144:147], a[152:155], v[16:31]
  v_mfma_f32_32x32x16_bf16 v[32:47], a[144:147], a[156:159], v[32:47]
  v_mfma_f32_32x32x16_bf16 v[48:63], a[148:151], a[152:155], v[48:63]
  v_mfma_f32_32x32x16_bf16 v[64:79], a[148:151], a[156:159], v[64:79]
  buffer_load_dwordx4 a[144:147], v4, s[12:15], s40 offen offset:1024
  buffer_load_dwordx4 a[152:155], v4, s[8:11], s42 offen offset:1024
  buffer_load_dwordx4 a[148:151], v4, s[12:15], s41 offen offset:1024
  buffer_load_dwordx4 a[156:159], v4, s[8:11], s43 offen offset:1024
  s_waitcnt vmcnt(46)
  v_mfma_f32_32x32x16_bf16 v[16:31], a[160:163], a[168:171], v[16:31]
  v_mfma_f32_32x32x16_bf16 v[32:47], a[160:163], a[172:175], v[32:47]
  v_mfma_f32_32x32x16_bf16 v[48:63], a[164:167], a[168:171], v[48:63]
  v_mfma_f32_32x32x16_bf16 v[64:79], a[164:167], a[172:175], v[64:79]
  buffer_load_dwordx4 a[160:163], v4, s[12:15], s40 offen offset:2048
  buffer_load_dwordx4 a[168:171], v4, s[8:11], s42 offen offset:2048
  buffer_load_dwordx4 a[164:167], v4, s[12:15], s41 offen offset:2048
  buffer_load_dwordx4 a[172:175], v4, s[8:11], s43 offen offset:2048
  s_waitcnt vmcnt(46)
  v_mfma_f32_32x32x16_bf16 v[16:31], a[176:179], a[184:187], v[16:31]
  v_mfma_f32_32x32x16_bf16 v[32:47], a[176:179], a[188:191], v[32:47]
  v_mfma_f32_32x32x16_bf16 v[48:63], a[180:183], a[184:187], v[48:63]
  v_mfma_f32_32x32x16_bf16 v[64:79], a[180:183], a[188:191], v[64:79]
  buffer_load_dwordx4 a[176:179], v4, s[12:15], s40 offen offset:3072
  buffer_load_dwordx4 a[184:187], v4, s[8:11], s42 offen offset:3072
  buffer_load_dwordx4 a[180:183], v4, s[12:15], s41 offen offset:3072
  buffer_load_dwordx4 a[188:191], v4, s[8:11], s43 offen offset:3072
  s_add_u32 s40, s40, 4096
  s_add_u32 s41, s41, 4096
  s_add_u32 s42, s42, 4096
  s_add_u32 s43, s43, 4096
  s_waitcnt vmcnt(44)
  v_mfma_f32_32x32x16_bf16 v[16:31], a[0:3], a[8:11], v[16:31]
  v_mfma_f32_32x32x16_bf16 v[32:47], a[0:3], a[12:15], v[32:47]
  v_mfma_f32_32x32x16_bf16 v[48:63], a[4:7], a[8:11], v[48:63]
  v_mfma_f32_32x32x16_bf16 v[64:79], a[4:7], a[12:15], v[64:79]
  buffer_load_dwordx4 a[0:3], v4, s[12:15], s40 offen offset:0
  buffer_load_dwordx4 a[8:11], v4, s[8:11], s42 offen offset:0
  buffer_load_dwordx4 a[4:7], v4, s[12:15], s41 offen offset:0
  buffer_load_dwordx4 a[12:15], v4, s[8:11], s43 offen offset:0
  s_waitcnt vmcnt(44)
  v_mfma_f32_32x32x16_bf16 v[16:31], a[16:19], a[24:27], v[16:31]
  v_mfma_f32_32x32x16_bf16 v[32:47], a[16:19], a[28:31], v[32:47]
  v_mfma_f32_32x32x16_bf16 v[48:63], a[20:23], a[24:27], v[48:63]
  v_mfma_f32_32x32x16_bf16 v[64:79], a[20:23], a[28:31], v[64:79]
  buffer_load_dwordx4 a[16:19], v4, s[12:15], s40 offen offset:1024
  buffer_load_dwordx4 a[24:27], v4, s[8:11], s42 offen offset:1024
  buffer_load_dwordx4 a[20:23], v4, s[12:15], s41 offen offset:1024
  buffer_load_dwordx4 a[28:31], v4, s[8:11], s43 offen offset:1024
  s_waitcnt vmcnt(44)
  v_mfma_f32_32x32x16_bf16 v[16:31], a[32:35], a[40:43], v[16:31]
  v_mfma_f32_32x32x16_bf16 v[32:47], a[32:35], a[44:47], v[32:47]
  v_mfma_f32_32x32x16_bf16 v[48:63], a[36:39], a[40:43], v[48:63]
  v_mfma_f32_32x32x16_bf16 v[64:79], a[36:39], a[44:47], v[64:79]
  buffer_load_dwordx4 a[32:35], v4, s[12:15], s40 offen offset:2048
  buffer_load_dwordx4 a[40:43], v4, s[8:11], s42 offen offset:2048
  buffer_load_dwordx4 a[36:39], v4, s[12:15], s41 offen offset:2048
  buffer_load_dwordx4 a[44:47], v4, s[8:11], s43 offen offset:2048
  s_waitcnt vmcnt(44)
  v_mfma_f32_32x32x16_bf16 v[16:31], a[48:51], a[56:59], v[16:31]
  v_mfma_f32_32x32x16_bf16 v[32:47], a[48:51], a[60:63], v[32:47]
  v_mfma_f32_32x32x16_bf16 v[48:63], a[52:55], a[56:59], v[48:63]
  v_mfma_f32_32x32x16_bf16 v[64:79], a[52:55], a[60:63], v[64:79]
  buffer_load_dwordx4 a[48:51], v4, s[12:15], s40 offen offset:3072
  buffer_load_dwordx4 a[56:59], v4, s[8:11], s42 offen offset:3072
  buffer_load_dwordx4 a[52:55], v4, s[12:15], s41 offen offset:3072
  buffer_load_dwordx4 a[60:63], v4, s[8:11], s43 offen offset:3072
  s_waitcnt vmcnt(44)
  v_mfma_f32_32x32x16_bf16 v[16:31], a[64:67], a[72:75], v[16:31]
  v_mfma_f32_32x32x16_bf16 v[32:47], a[64:67], a[76:79], v[32:47]
  v_mfma_f32_32x32x16_bf16 v[48:63], a[68:71], a[72:75], v[48:63]
  v_mfma_f32_32x32x16_bf16 v[64:79], a[68:71], a[76:79], v[64:79]
  s_waitcnt vmcnt(40)
  v_mfma_f32_32x32x16_bf16 v[16:31], a[80:83], a[88:91], v[16:31]
  v_mfma_f32_32x32x16_bf16 v[32:47], a[80:83], a[92:95], v[32:47]
  v_mfma_f32_32x32x16_bf16 v[48:63], a[84:87], a[88:91], v[48:63]
  v_mfma_f32_32x32x16_bf16 v[64:79], a[84:87], a[92:95], v[64:79]
  s_waitcnt vmcnt(36)
  v_mfma_f32_32x32x16_bf16 v[16:31], a[96:99], a[104:107], v[16:31]
  v_mfma_f32_32x32x16_bf16 v[32:47], a[96:99], a[108:111], v[32:47]
  v_mfma_f32_32x32x16_bf16 v[48:63], a[100:103], a[104:107], v[48:63]
  v_mfma_f32_32x32x16_bf16 v[64:79], a[100:103], a[108:111], v[64:79]
  s_waitcnt vmcnt(32)
  v_mfma_f32_32x32x16_bf16 v[16:31], a[112:115], a[120:123], v[16:31]
  v_mfma_f32_32x32x16_bf16 v[32:47], a[112:115], a[124:127], v[32:47]
  v_mfma_f32_32x32x16_bf16 v[48:63], a[116:119], a[120:123], v[48:63]
  v_mfma_f32_32x32x16_bf16 v[64:79], a[116:119], a[124:127], v[64:79]
  s_waitcnt vmcnt(28)
  v_mfma_f32_32x32x16_bf16 v[16:31], a[128:131], a[136:139], v[16:31]
  v_mfma_f32_32x32x16_bf16 v[32:47], a[128:131], a[140:143], v[32:47]
  v_mfma_f32_32x32x16_bf16 v[48:63], a[132:135], a[136:139], v[48:63]
  v_mfma_f32_32x32x16_bf16 v[64:79], a[132:135], a[140:143], v[64:79]
  s_waitcnt vmcnt(24)
  v_mfma_f32_32x32x16_bf16 v[16:31], a[144:147], a[152:155], v[16:31]
  v_mfma_f32_32x32x16_bf16 v[32:47], a[144:147], a[156:159], v[32:47]
  v_mfma_f32_32x32x16_bf16 v[48:63], a[148:151], a[152:155], v[48:63]
  v_mfma_f32_32x32x16_bf16 v[64:79], a[148:151], a[156:159], v[64:79]
  s_waitcnt vmcnt(20)
  v_mfma_f32_32x32x16_bf16 v[16:31], a[160:163], a[168:171], v[16:31]
  v_mfma_f32_32x32x16_bf16 v[32:47], a[160:163], a[172:175], v[32:47]
  v_mfma_f32_32x32x16_bf16 v[48:63], a[164:167], a[168:171], v[48:63]
  v_mfma_f32_32x32x16_bf16 v[64:79], a[164:167], a[172:175], v[64:79]
  s_waitcnt vmcnt(16)
  v_mfma_f32_32x32x16_bf16 v[16:31], a[176:179], a[184:187], v[16:31]
  v_mfma_f32_32x32x16_bf16 v[32:47], a[176:179], a[188:191], v[32:47]
  v_mfma_f32_32x32x16_bf16 v[48:63], a[180:183], a[184:187], v[48:63]
  v_mfma_f32_32x32x16_bf16 v[64:79], a[180:183], a[188:191], v[64:79]
  s_waitcnt vmcnt(12)
  v_mfma_f32_32x32x16_bf16 v[16:31], a[0:3], a[8:11], v[16:31]
  v_mfma_f32_32x32x16_bf16 v[32:47], a[0:3], a[12:15], v[32:47]
  v_mfma_f32_32x32x16_bf16 v[48:63], a[4:7], a[8:11], v[48:63]
  v_mfma_f32_32x32x16_bf16 v[64:79], a[4:7], a[12:15], v[64:79]
  s_waitcnt vmcnt(8)
  v_mfma_f32_32x32x16_bf16 v[16:31], a[16:19], a[24:27], v[16:31]
  v_mfma_f32_32x32x16_bf16 v[32:47], a[16:19], a[28:31], v[32:47]
  v_mfma_f32_32x32x16_bf16 v[48:63], a[20:23], a[24:27], v[48:63]
  v_mfma_f32_32x32x16_bf16 v[64:79], a[20:23], a[28:31], v[64:79]
  s_waitcnt vmcnt(4)
  v_mfma_f32_32x32x16_bf16 v[16:31], a[32:35], a[40:43], v[16:31]
  v_mfma_f32_32x32x16_bf16 v[32:47], a[32:35], a[44:47], v[32:47]
  v_mfma_f32_32x32x16_bf16 v[48:63], a[36:39], a[40:43], v[48:63]
  v_mfma_f32_32x32x16_bf16 v[64:79], a[36:39], a[44:47], v[64:79]
  s_waitcnt vmcnt(0)
  v_mfma_f32_32x32x16_bf16 v[16:31], a[48:51], a[56:59], v[16:31]
  v_mfma_f32_32x32x16_bf16 v[32:47], a[48:51], a[60:63], v[32:47]
  v_mfma_f32_32x32x16_bf16 v[48:63], a[52:55], a[56:59], v[48:63]
  v_mfma_f32_32x32x16_bf16 v[64:79], a[52:55], a[60:63], v[64:79]
  s_nop 9
  ds_write_b128 v9, v[32:35] offset:0
  ds_write_b128 v9, v[36:39] offset:1024
  ds_write_b128 v9, v[40:43] offset:2048
  ds_write_b128 v9, v[44:47] offset:3072
  ds_write_b128 v10, v[48:51] offset:0
  ds_write_b128 v10, v[52:55] offset:1024
  ds_write_b128 v10, v[56:59] offset:2048
  ds_write_b128 v10, v[60:63] offset:3072
  s_nop 3
  ds_write_b128 v11, v[64:67] offset:0
  ds_write_b128 v11, v[68:71] offset:1024
  ds_write_b128 v11, v[72:75] offset:2048
  ds_write_b128 v11, v[76:79] offset:3072
  s_waitcnt lgkmcnt(0)
  s_barrier
  ds_read_b128 v[32:35], v8 offset:0
  ds_read_b128 v[36:39], v8 offset:1024
  ds_read_b128 v[40:43], v8 offset:2048
  ds_read_b128 v[44:47], v8 offset:3072
  ds_read_b128 v[48:51], v8 offset:4096
  ds_read_b128 v[52:55], v8 offset:5120
  ds_read_b128 v[56:59], v8 offset:6144
  ds_read_b128 v[60:63], v8 offset:7168
  ds_read_b128 v[64:67], v8 offset:8192
  ds_read_b128 v[68:71], v8 offset:9216
  ds_read_b128 v[72:75], v8 offset:10240
  ds_read_b128 v[76:79], v8 offset:11264
  v_lshlrev_b32 v96, 16, v80
  v_and_b32 v97, 0xffff0000, v80
  v_add_f32 v16, v16, v96
  v_add_f32 v17, v17, v97
  v_lshlrev_b32 v96, 16, v81
  v_and_b32 v97, 0xffff0000, v81
  v_add_f32 v18, v18, v96
  v_add_f32 v19, v19, v97
  v_lshlrev_b32 v96, 16, v82
  v_and_b32 v97, 0xffff0000, v82
  v_add_f32 v20, v20, v96
  v_add_f32 v21, v21, v97
  v_lshlrev_b32 v96, 16, v83
  v_and_b32 v97, 0xffff0000, v83
  v_add_f32 v22, v22, v96
  v_add_f32 v23, v23, v97
  v_lshlrev_b32 v96, 16, v84
  v_and_b32 v97, 0xffff0000, v84
  v_add_f32 v24, v24, v96
  v_add_f32 v25, v25, v97
  v_lshlrev_b32 v96, 16, v85
  v_and_b32 v97, 0xffff0000, v85
  v_add_f32 v26, v26, v96
  v_add_f32 v27, v27, v97
  v_lshlrev_b32 v96, 16, v86
  v_and_b32 v97, 0xffff0000, v86
  v_add_f32 v28, v28, v96
  v_add_f32 v29, v29, v97
  v_lshlrev_b32 v96, 16, v87
  v_and_b32 v97, 0xffff0000, v87
  v_add_f32 v30, v30, v96
  v_add_f32 v31, v31, v97
  s_waitcnt lgkmcnt(8)
  v_add_f32 v16, v16, v32
  v_add_f32 v17, v17, v33
  v_add_f32 v18, v18, v34
  v_add_f32 v19, v19, v35
  v_add_f32 v20, v20, v36
  v_add_f32 v21, v21, v37
  v_add_f32 v22, v22, v38
  v_add_f32 v23, v23, v39
  v_add_f32 v24, v24, v40
  v_add_f32 v25, v25, v41
  v_add_f32 v26, v26, v42
  v_add_f32 v27, v27, v43
  v_add_f32 v28, v28, v44
  v_add_f32 v29, v29, v45
  v_add_f32 v30, v30, v46
  v_add_f32 v31, v31, v47
  s_waitcnt lgkmcnt(4)
  v_add_f32 v16, v16, v48
  v_add_f32 v17, v17, v49
  v_add_f32 v18, v18, v50
  v_add_f32 v19, v19, v51
  v_add_f32 v20, v20, v52
  v_add_f32 v21, v21, v53
  v_add_f32 v22, v22, v54
  v_add_f32 v23, v23, v55
  v_add_f32 v24, v24, v56
  v_add_f32 v25, v25, v57
  v_add_f32 v26, v26, v58
  v_add_f32 v27, v27, v59
  v_add_f32 v28, v28, v60
  v_add_f32 v29, v29, v61
  v_add_f32 v30, v30, v62
  v_add_f32 v31, v31, v63
  s_waitcnt lgkmcnt(0)
  v_add_f32 v16, v16, v64
  v_add_f32 v17, v17, v65
  v_add_f32 v18, v18, v66
  v_add_f32 v19, v19, v67
  v_add_f32 v20, v20, v68
  v_add_f32 v21, v21, v69
  v_add_f32 v22, v22, v70
  v_add_f32 v23, v23, v71
  v_add_f32 v24, v24, v72
  v_add_f32 v25, v25, v73
  v_add_f32 v26, v26, v74
  v_add_f32 v27, v27, v75
  v_add_f32 v28, v28, v76
  v_add_f32 v29, v29, v77
  v_add_f32 v30, v30, v78
  v_add_f32 v31, v31, v79
  v_cvt_pk_bf16_f32 v88, v16, v17
  v_cvt_pk_bf16_f32 v89, v18, v19
  v_cvt_pk_bf16_f32 v90, v20, v21
  v_cvt_pk_bf16_f32 v91, v22, v23
  v_cvt_pk_bf16_f32 v92, v24, v25
  v_cvt_pk_bf16_f32 v93, v26, v27
  v_cvt_pk_bf16_f32 v94, v28, v29
  v_cvt_pk_bf16_f32 v95, v30, v31
  s_nop 1
  v_permlane32_swap_b32 v88, v90
  v_permlane32_swap_b32 v89, v91
  v_permlane32_swap_b32 v92, v94
  v_permlane32_swap_b32 v93, v95
  s_nop 1
  buffer_store_dwordx4 v[88:91], v5, s[20:23], s46 offen
  buffer_store_dwordx4 v[92:95], v5, s[20:23], s46 offen offset:32
ffn2_last_kernel_exit:
  s_endpgm
.section .rodata,"a"
.p2align 6
.amdhsa_kernel prep_kernel
  .amdhsa_next_free_vgpr 128
  .amdhsa_next_free_sgpr 96
  .amdhsa_accum_offset 128
  .amdhsa_group_segment_fixed_size 0
  .amdhsa_kernarg_size 72
  .amdhsa_user_sgpr_count 2
  .amdhsa_user_sgpr_kernarg_segment_ptr 1
  .amdhsa_system_sgpr_workgroup_id_x 1
.end_amdhsa_kernel
.section .rodata,"a"
.p2align 6
.amdhsa_kernel qkv_kernel
  .amdhsa_next_free_vgpr 308
  .amdhsa_next_free_sgpr 96
  .amdhsa_accum_offset 180
  .amdhsa_group_segment_fixed_size 0
  .amdhsa_kernarg_size 72
  .amdhsa_user_sgpr_count 2
  .amdhsa_user_sgpr_kernarg_segment_ptr 1
  .amdhsa_system_sgpr_workgroup_id_x 1
.end_amdhsa_kernel
.section .rodata,"a"
.p2align 6
.amdhsa_kernel attn_kernel
  .amdhsa_next_free_vgpr 112
  .amdhsa_next_free_sgpr 96
  .amdhsa_accum_offset 112
  .amdhsa_group_segment_fixed_size 0
  .amdhsa_kernarg_size 72
  .amdhsa_user_sgpr_count 2
  .amdhsa_user_sgpr_kernarg_segment_ptr 1
  .amdhsa_system_sgpr_workgroup_id_x 1
.end_amdhsa_kernel
.section .rodata,"a"
.p2align 6
.amdhsa_kernel outp_kernel
  .amdhsa_next_free_vgpr 240
  .amdhsa_next_free_sgpr 96
  .amdhsa_accum_offset 112
  .amdhsa_group_segment_fixed_size 0
  .amdhsa_kernarg_size 72
  .amdhsa_user_sgpr_count 2
  .amdhsa_user_sgpr_kernarg_segment_ptr 1
  .amdhsa_system_sgpr_workgroup_id_x 1
.end_amdhsa_kernel
.section .rodata,"a"
.p2align 6
.amdhsa_kernel ffn1_kernel
  .amdhsa_next_free_vgpr 308
  .amdhsa_next_free_sgpr 96
  .amdhsa_accum_offset 180
  .amdhsa_group_segment_fixed_size 0
  .amdhsa_kernarg_size 72
  .amdhsa_user_sgpr_count 2
  .amdhsa_user_sgpr_kernarg_segment_ptr 1
  .amdhsa_system_sgpr_workgroup_id_x 1
.end_amdhsa_kernel
.section .rodata,"a"
.p2align 6
.amdhsa_kernel ffn2_kernel
  .amdhsa_next_free_vgpr 304
  .amdhsa_next_free_sgpr 96
  .amdhsa_accum_offset 112
  .amdhsa_group_segment_fixed_size 0
  .amdhsa_kernarg_size 72
  .amdhsa_user_sgpr_count 2
  .amdhsa_user_sgpr_kernarg_segment_ptr 1
  .amdhsa_system_sgpr_workgroup_id_x 1
.end_amdhsa_kernel
.section .rodata,"a"
.p2align 6
.amdhsa_kernel ffn2_last_kernel
  .amdhsa_next_free_vgpr 304
  .amdhsa_next_free_sgpr 96
  .amdhsa_accum_offset 112
  .amdhsa_group_segment_fixed_size 0
  .amdhsa_kernarg_size 72
  .amdhsa_user_sgpr_count 2
  .amdhsa_user_sgpr_kernarg_segment_ptr 1
  .amdhsa_system_sgpr_workgroup_id_x 1
.end_amdhsa_kernel
```
